```python
import torch

def _softmax(x, axis=-1):
    return torch.softmax(x, dim=axis)
def _gelu(x):
    return torch.nn.functional.gelu(x, approximate="tanh")
def _silu(x):
    return torch.nn.functional.silu(x)
def _sigmoid(x):
    return torch.sigmoid(x)
def _layernorm(x, axis=-1, eps=1e-5):
    m = x.mean(dim=axis, keepdim=True)
    v = x.var(dim=axis, keepdim=True, unbiased=False)
    return (x - m) / torch.sqrt(v + eps)
def _scatter_add(tgt, idx, src, axis=0):
    return tgt.clone().index_add_(axis, idx, src)
def _segment_sum(src, seg, n):
    out = torch.zeros((n,) + src.shape[1:], dtype=src.dtype)
    return out.index_add_(0, seg, src)
def _pad(x, pw):
    flat = tuple(v for pair in reversed(pw) for v in pair)
    return torch.nn.functional.pad(x, flat)

kernel_name = 'recurrent_scan__spectral_gfnet__moe_arch_mod__prompt'

def setup_inputs():

    _w = (lambda a: (lambda t: t.to(torch.bfloat16) if t.is_floating_point() else t)(torch.as_tensor(a)))
    def _A_setup():
        B, S, D = 1, 2048, 1024
        Df = D // 2 + 1
        return {
            "x": _w((lambda *s: torch.randn(*s, dtype=torch.bfloat16) * 0.05)(B, S, D)),
            "w_r": _w((lambda *s: torch.randn(*s, dtype=torch.bfloat16) * 0.05)(S, Df) * 0.02),
            "w_i": _w((lambda *s: torch.randn(*s, dtype=torch.bfloat16) * 0.05)(S, Df) * 0.02),
        }
    _A_in = _A_setup()

    def _B_setup():
        B, S, D, F, C = 1, 2048, 1024, 3584, 1
        return {
            "x": _w((lambda *s: torch.randn(*s, dtype=torch.bfloat16) * 0.05)(B, S, D)),
            "w_r": _w((lambda *s: torch.randn(*s, dtype=torch.bfloat16) * 1.6)(D)),
            "w_gate": _w((lambda *s: torch.randn(*s, dtype=torch.bfloat16) * 0.1)(D, F)),
            "w_up": _w((lambda *s: torch.randn(*s, dtype=torch.bfloat16) * 0.1)(D, F)),
            "w_down": _w((lambda *s: torch.randn(*s, dtype=torch.bfloat16) * 0.1)(F, D)),
        }
    _B_in = _B_setup()

    return {
        "A_x": _A_in["x"],
        "A_w_r": _A_in["w_r"],
        "A_w_i": _A_in["w_i"],
        "B_x": _B_in["x"],
        "B_w_r": _B_in["w_r"],
        "B_w_gate": _B_in["w_gate"],
        "B_w_up": _B_in["w_up"],
        "B_w_down": _B_in["w_down"],
    }

def reference(A_x, A_w_r, A_w_i, B_x, B_w_r, B_w_gate, B_w_up, B_w_down):
    def _A_ref(x, w_r, w_i):
        B, S, D = x.shape
        X = (lambda x, axes=(-2,-1): torch.fft.rfft2(x.float(), dim=axes))(x, axes=(-2, -1))
        W = w_r + 1j * w_i
        X = X * W
        y = (lambda x, s, axes=(-2,-1): torch.fft.irfft2(x, s=s, dim=axes).to(torch.bfloat16))(X, (S, D), axes=(-2, -1))
        return y

    def _B_ref(x, w_r, w_gate, w_up, w_down):
        B, S, D = x.shape
        C = 1
        r = x @ w_r
        idx = torch.argsort(-r, axis=-1)[:, :C]
        idx_e = (lambda x, n, axis: torch.repeat_interleave(x, n, dim=axis))(idx.reshape(B, C, 1), D, axis=2)
        x_sel = (lambda x, i, axis: torch.take_along_dim(x, i, dim=axis))(x, idx_e, axis=1)
        g = _silu(x_sel @ w_gate)
        u = x_sel @ w_up
        y = (g * u) @ w_down
        r_sel = _sigmoid((lambda x, i, axis: torch.take_along_dim(x, i, dim=axis))(r, idx, axis=1))
        y = y * r_sel.reshape(B, C, 1)
        b_off = (torch.arange(B) * S).reshape(B, 1)
        flat_idx = (idx + b_off).reshape(B * C)
        zero = (x * 0.0).reshape(B * S, D)
        upd = _scatter_add(zero, flat_idx, y.reshape(B * C, D), axis=0)
        return x + upd.reshape(B, S, D)

    x = A_x
    xn = _layernorm(x, axis=-1)
    s = _A_ref(xn, A_w_r, A_w_i)
    g = _silu(_B_ref(xn, B_w_r, B_w_gate, B_w_up, B_w_down))
    return x + s * g
```

```asm
; @launch kernel=fft_k1_kernel grid=(512,1,1) block=(256,1,1) lds=35072
; @launch kernel=fft_k23_kernel grid=(512,1,1) block=(256,1,1) lds=69632
.amdgcn_target "amdgcn-amd-amdhsa--gfx950"
.text
.globl fft_k1_kernel
.p2align 8
.type fft_k1_kernel,@function
fft_k1_kernel:
  s_cmp_lt_u32 s2, 256
  s_cbranch_scc1 K1_FFT
  s_cmp_lt_u32 s2, 512
  s_cbranch_scc1 K1_PRE
  s_endpgm
K1_FFT:
  s_setprio 3
  s_load_dwordx2 s[4:5], s[0:1], 0
  s_load_dwordx2 s[6:7], s[0:1], 32
  s_load_dwordx2 s[8:9], s[0:1], 80
  v_lshrrev_b32 v3, 6, v0
  v_and_b32 v1, 63, v0
  v_readfirstlane_b32 s3, v3
  v_lshlrev_b32 v2, 4, v1
  s_lshr_b32 s10, s2, 5
  s_lshl_b32 s10, s10, 7
  s_and_b32 s11, s2, 31
  s_add_u32 s10, s10, s11
  s_lshl_b32 s11, s3, 5
  s_add_u32 s10, s10, s11
  s_lshl_b32 s11, s10, 12
  v_lshlrev_b32 v4, 7, v1
  s_getpc_b64 s[44:45]
CP_24:
  s_sub_u32 s44, s44, CP_24-K1_FFT
  s_subb_u32 s45, s45, 0
  global_load_dword v239, v4, s[44:45]
  s_waitcnt lgkmcnt(0)
  s_mov_b32 s12, s4
  s_mov_b32 s13, s5
  s_mov_b32 s14, 0x400000
  s_mov_b32 s15, 0x20000
  s_mov_b32 s16, s6
  s_mov_b32 s17, s7
  s_mov_b32 s18, 0x800
  s_mov_b32 s19, 0x20000
  buffer_load_dwordx4 v[136:139], v2, s[12:15], s11 offen offset:0
  buffer_load_dwordx4 v[140:143], v2, s[12:15], s11 offen offset:1024
  buffer_load_dwordx4 v[144:147], v2, s[12:15], s11 offen offset:2048
  buffer_load_dwordx4 v[148:151], v2, s[12:15], s11 offen offset:3072
  buffer_load_dwordx4 v[152:155], v2, s[16:19], 0 offen offset:0
  buffer_load_dwordx4 v[156:159], v2, s[16:19], 0 offen offset:1024
  s_add_u32 s20, s8, 0x1000000
  s_addc_u32 s21, s9, 0
  s_mov_b32 s22, 0x400000
  s_mov_b32 s23, 0x20000
  s_add_u32 s24, s8, 0xe80000
  s_addc_u32 s25, s9, 0
  s_mov_b32 s26, 0x8000
  s_mov_b32 s27, 0x20000
  v_and_b32 v4, 31, v1
  v_cvt_f32_u32 v4, v4
  v_lshrrev_b32 v5, 5, v1
  v_cvt_f32_u32 v5, v5
  v_mul_f32 v4, 0x3d000000, v4
  v_mul_f32 v5, 4.0, v5
  v_mul_f32_e64 v5, v4, v5
  v_fmamk_f32 v32, v4, 0x00000000, v5
  v_fmamk_f32 v33, v4, 0x3f800000, v5
  v_fmamk_f32 v34, v4, 0x40000000, v5
  v_fmamk_f32 v35, v4, 0x40400000, v5
  v_fmamk_f32 v36, v4, 0x41000000, v5
  v_fmamk_f32 v37, v4, 0x41100000, v5
  v_fmamk_f32 v38, v4, 0x41200000, v5
  v_fmamk_f32 v39, v4, 0x41300000, v5
  v_fmamk_f32 v40, v4, 0x41800000, v5
  v_fmamk_f32 v41, v4, 0x41880000, v5
  v_fmamk_f32 v42, v4, 0x41900000, v5
  v_fmamk_f32 v43, v4, 0x41980000, v5
  v_fmamk_f32 v44, v4, 0x41c00000, v5
  v_fmamk_f32 v45, v4, 0x41c80000, v5
  v_fmamk_f32 v46, v4, 0x41d00000, v5
  v_fmamk_f32 v47, v4, 0x41d80000, v5
  v_mul_f32 v120, 0x3d000000, v32
  v_mul_f32 v121, 0x3d000000, v33
  v_mul_f32 v122, 0x3d000000, v34
  v_mul_f32 v123, 0x3d000000, v35
  v_mul_f32 v124, 0x3d000000, v36
  v_mul_f32 v125, 0x3d000000, v37
  v_mul_f32 v126, 0x3d000000, v38
  v_mul_f32 v127, 0x3d000000, v39
  v_mul_f32 v128, 0x3d000000, v40
  v_mul_f32 v129, 0x3d000000, v41
  v_mul_f32 v130, 0x3d000000, v42
  v_mul_f32 v131, 0x3d000000, v43
  v_mul_f32 v132, 0x3d000000, v44
  v_mul_f32 v133, 0x3d000000, v45
  v_mul_f32 v134, 0x3d000000, v46
  v_mul_f32 v135, 0x3d000000, v47
  v_cos_f32 v104, v120
  v_cos_f32 v105, v121
  v_cos_f32 v106, v122
  v_cos_f32 v107, v123
  v_cos_f32 v108, v124
  v_cos_f32 v109, v125
  v_cos_f32 v110, v126
  v_cos_f32 v111, v127
  v_cos_f32 v112, v128
  v_cos_f32 v113, v129
  v_cos_f32 v114, v130
  v_cos_f32 v115, v131
  v_cos_f32 v116, v132
  v_cos_f32 v117, v133
  v_cos_f32 v118, v134
  v_cos_f32 v119, v135
  v_sin_f32 v120, v120
  v_sin_f32 v121, v121
  v_sin_f32 v122, v122
  v_sin_f32 v123, v123
  v_sin_f32 v124, v124
  v_sin_f32 v125, v125
  v_sin_f32 v126, v126
  v_sin_f32 v127, v127
  v_sin_f32 v128, v128
  v_sin_f32 v129, v129
  v_sin_f32 v130, v130
  v_sin_f32 v131, v131
  v_sin_f32 v132, v132
  v_sin_f32 v133, v133
  v_sin_f32 v134, v134
  v_sin_f32 v135, v135
  v_cos_f32 v16, v32
  v_cos_f32 v17, v33
  v_cos_f32 v18, v34
  v_cos_f32 v19, v35
  v_cos_f32 v20, v36
  v_cos_f32 v21, v37
  v_cos_f32 v22, v38
  v_cos_f32 v23, v39
  v_cos_f32 v24, v40
  v_cos_f32 v25, v41
  v_cos_f32 v26, v42
  v_cos_f32 v27, v43
  v_cos_f32 v28, v44
  v_cos_f32 v29, v45
  v_cos_f32 v30, v46
  v_cos_f32 v31, v47
  v_sin_f32 v32, v32
  v_sin_f32 v33, v33
  v_sin_f32 v34, v34
  v_sin_f32 v35, v35
  v_sin_f32 v36, v36
  v_sin_f32 v37, v37
  v_sin_f32 v38, v38
  v_sin_f32 v39, v39
  v_sin_f32 v40, v40
  v_sin_f32 v41, v41
  v_sin_f32 v42, v42
  v_sin_f32 v43, v43
  v_sin_f32 v44, v44
  v_sin_f32 v45, v45
  v_sin_f32 v46, v46
  v_sin_f32 v47, v47
  v_cvt_pk_bf16_f32 v48, v16, v32
  v_cvt_pk_bf16_f32 v49, v17, v33
  v_cvt_pk_bf16_f32 v50, v18, v34
  v_cvt_pk_bf16_f32 v51, v19, v35
  v_cvt_pk_bf16_f32 v52, v20, v36
  v_cvt_pk_bf16_f32 v53, v21, v37
  v_cvt_pk_bf16_f32 v54, v22, v38
  v_cvt_pk_bf16_f32 v55, v23, v39
  v_cvt_pk_bf16_f32 v56, v24, v40
  v_cvt_pk_bf16_f32 v57, v25, v41
  v_cvt_pk_bf16_f32 v58, v26, v42
  v_cvt_pk_bf16_f32 v59, v27, v43
  v_cvt_pk_bf16_f32 v60, v28, v44
  v_cvt_pk_bf16_f32 v61, v29, v45
  v_cvt_pk_bf16_f32 v62, v30, v46
  v_cvt_pk_bf16_f32 v63, v31, v47
  v_cvt_pk_bf16_f32 v64, -v32, v16
  v_cvt_pk_bf16_f32 v65, -v33, v17
  v_cvt_pk_bf16_f32 v66, -v34, v18
  v_cvt_pk_bf16_f32 v67, -v35, v19
  v_cvt_pk_bf16_f32 v68, -v36, v20
  v_cvt_pk_bf16_f32 v69, -v37, v21
  v_cvt_pk_bf16_f32 v70, -v38, v22
  v_cvt_pk_bf16_f32 v71, -v39, v23
  v_cvt_pk_bf16_f32 v72, -v40, v24
  v_cvt_pk_bf16_f32 v73, -v41, v25
  v_cvt_pk_bf16_f32 v74, -v42, v26
  v_cvt_pk_bf16_f32 v75, -v43, v27
  v_cvt_pk_bf16_f32 v76, -v44, v28
  v_cvt_pk_bf16_f32 v77, -v45, v29
  v_cvt_pk_bf16_f32 v78, -v46, v30
  v_cvt_pk_bf16_f32 v79, -v47, v31
  v_cvt_pk_bf16_f32 v80, v16, v17
  v_cvt_pk_bf16_f32 v88, -v32, -v33
  v_cvt_pk_bf16_f32 v96, v32, v33
  v_cvt_pk_bf16_f32 v81, v18, v19
  v_cvt_pk_bf16_f32 v89, -v34, -v35
  v_cvt_pk_bf16_f32 v97, v34, v35
  v_cvt_pk_bf16_f32 v82, v20, v21
  v_cvt_pk_bf16_f32 v90, -v36, -v37
  v_cvt_pk_bf16_f32 v98, v36, v37
  v_cvt_pk_bf16_f32 v83, v22, v23
  v_cvt_pk_bf16_f32 v91, -v38, -v39
  v_cvt_pk_bf16_f32 v99, v38, v39
  v_cvt_pk_bf16_f32 v84, v24, v25
  v_cvt_pk_bf16_f32 v92, -v40, -v41
  v_cvt_pk_bf16_f32 v100, v40, v41
  v_cvt_pk_bf16_f32 v85, v26, v27
  v_cvt_pk_bf16_f32 v93, -v42, -v43
  v_cvt_pk_bf16_f32 v101, v42, v43
  v_cvt_pk_bf16_f32 v86, v28, v29
  v_cvt_pk_bf16_f32 v94, -v44, -v45
  v_cvt_pk_bf16_f32 v102, v44, v45
  v_cvt_pk_bf16_f32 v87, v30, v31
  v_cvt_pk_bf16_f32 v95, -v46, -v47
  v_cvt_pk_bf16_f32 v103, v46, v47
  v_and_b32 v4, 31, v1
  v_lshrrev_b32 v5, 5, v1
  v_lshlrev_b32 v5, 4, v5
  v_mul_u32_u24 v8, 144, v4
  v_add_u32 v8, v5, v8
  s_mul_i32 s40, s3, 4672
  s_add_u32 s40, s40, 16384
  v_add_u32 v8, s40, v8
  v_and_b32 v9, 3, v4
  v_mul_u32_u24 v9, 4672, v9
  v_lshrrev_b32 v4, 2, v4
  v_mul_u32_u24 v4, 144, v4
  v_add3_u32 v9, v9, v4, v5
  s_mul_i32 s40, s3, 1152
  s_add_u32 s40, s40, 16384
  v_add_u32 v9, s40, v9
  v_and_b32 v4, 31, v1
  v_lshrrev_b32 v10, 3, v4
  v_lshlrev_b32 v10, 5, v10
  v_lshrrev_b32 v5, 5, v1
  v_add_u32_e64 v10, v5, v10
  v_mul_u32_u24 v10, 32768, v10
  v_bfe_u32 v5, v4, 2, 1
  v_lshl_add_u32 v10, v5, 6, v10
  s_lshr_b32 s40, s2, 2
  s_and_b32 s40, s40, 3
  v_and_b32 v4, 3, v4
  v_xor_b32 v4, s40, v4
  v_lshlrev_b32 v4, 4, v4
  v_add_u32 v10, v4, v10
  v_lshrrev_b32 v4, 5, v1
  v_lshlrev_b32 v4, 8, v4
  v_bfe_u32 v5, v1, 2, 2
  v_lshlrev_b32 v5, 6, v5
  v_bfe_u32 v6, v1, 4, 1
  v_lshlrev_b32 v6, 5, v6
  v_add3_u32 v4, v4, v5, v6
  v_and_b32 v5, 3, v1
  v_lshlrev_b32 v5, 3, v5
  s_lshl_b32 s28, s3, 12
  v_add3_u32 v11, v4, v5, s28
  v_add_u32 v12, s28, v2
  s_mov_b32 s29, 0x3f803f80
  s_mov_b32 s30, 0xffff0000
  v_mov_b32 v4, 0
  v_mov_b32 v6, 0
  s_waitcnt vmcnt(5)
  v_dot2c_f32_bf16 v4, s29, v136
  s_waitcnt vmcnt(3)
  v_dot2c_f32_bf16 v6, s29, v144
  v_dot2c_f32_bf16 v4, s29, v137
  v_dot2c_f32_bf16 v6, s29, v145
  v_dot2c_f32_bf16 v4, s29, v138
  v_dot2c_f32_bf16 v6, s29, v146
  v_dot2c_f32_bf16 v4, s29, v139
  v_dot2c_f32_bf16 v6, s29, v147
  v_dot2c_f32_bf16 v4, s29, v140
  s_waitcnt vmcnt(2)
  v_dot2c_f32_bf16 v6, s29, v148
  v_dot2c_f32_bf16 v4, s29, v141
  v_dot2c_f32_bf16 v6, s29, v149
  v_dot2c_f32_bf16 v4, s29, v142
  v_dot2c_f32_bf16 v6, s29, v150
  v_dot2c_f32_bf16 v4, s29, v143
  v_dot2c_f32_bf16 v6, s29, v151
  v_lshlrev_b32 v160, 16, v136
  v_and_b32 v161, s30, v136
  v_lshlrev_b32 v162, 16, v137
  v_and_b32 v163, s30, v137
  v_lshlrev_b32 v164, 16, v138
  v_and_b32 v165, s30, v138
  v_lshlrev_b32 v166, 16, v139
  v_and_b32 v167, s30, v139
  v_lshlrev_b32 v168, 16, v140
  v_and_b32 v169, s30, v140
  v_lshlrev_b32 v170, 16, v141
  v_and_b32 v171, s30, v141
  v_lshlrev_b32 v172, 16, v142
  v_and_b32 v173, s30, v142
  v_lshlrev_b32 v174, 16, v143
  v_and_b32 v175, s30, v143
  v_lshlrev_b32 v176, 16, v144
  v_and_b32 v177, s30, v144
  v_lshlrev_b32 v178, 16, v145
  v_and_b32 v179, s30, v145
  v_lshlrev_b32 v180, 16, v146
  v_and_b32 v181, s30, v146
  v_lshlrev_b32 v182, 16, v147
  v_and_b32 v183, s30, v147
  v_lshlrev_b32 v184, 16, v148
  v_and_b32 v185, s30, v148
  v_lshlrev_b32 v186, 16, v149
  v_and_b32 v187, s30, v149
  v_lshlrev_b32 v188, 16, v150
  v_and_b32 v189, s30, v150
  v_lshlrev_b32 v190, 16, v151
  v_and_b32 v191, s30, v151
  v_add_f32_dpp v4, v4, v4 quad_perm:[1,0,3,2] row_mask:0xf bank_mask:0xf
  v_add_f32_dpp v6, v6, v6 quad_perm:[1,0,3,2] row_mask:0xf bank_mask:0xf
  s_nop 0
  v_add_f32_dpp v4, v4, v4 quad_perm:[2,3,0,1] row_mask:0xf bank_mask:0xf
  v_add_f32_dpp v6, v6, v6 quad_perm:[2,3,0,1] row_mask:0xf bank_mask:0xf
  s_nop 0
  v_add_f32_dpp v4, v4, v4 row_half_mirror row_mask:0xf bank_mask:0xf
  v_add_f32_dpp v6, v6, v6 row_half_mirror row_mask:0xf bank_mask:0xf
  s_nop 0
  v_add_f32_dpp v4, v4, v4 row_mirror row_mask:0xf bank_mask:0xf
  v_add_f32_dpp v6, v6, v6 row_mirror row_mask:0xf bank_mask:0xf
  v_mov_b32 v14, v4
  v_mov_b32 v15, v6
  s_nop 0
  v_permlane16_swap_b32 v14, v4
  v_permlane16_swap_b32 v15, v6
  v_add_f32 v4, v14, v4
  v_add_f32 v6, v15, v6
  v_mov_b32 v14, v4
  v_mov_b32 v15, v6
  s_nop 0
  v_permlane32_swap_b32 v14, v4
  v_permlane32_swap_b32 v15, v6
  v_add_f32 v4, v14, v4
  v_add_f32 v6, v15, v6
  v_mul_f32 v224, 0x3a800000, v4
  v_mul_f32 v225, 0x3a800000, v6
  v_cvt_pk_bf16_f32 v14, v224, v225
  v_lshlrev_b32 v226, 16, v14
  v_and_b32 v228, s30, v14
  v_pk_add_f32 v[160:161], v[160:161], v[226:227] op_sel_hi:[1,0] neg_lo:[0,1] neg_hi:[0,1]
  v_pk_add_f32 v[162:163], v[162:163], v[226:227] op_sel_hi:[1,0] neg_lo:[0,1] neg_hi:[0,1]
  v_pk_add_f32 v[164:165], v[164:165], v[226:227] op_sel_hi:[1,0] neg_lo:[0,1] neg_hi:[0,1]
  v_pk_add_f32 v[166:167], v[166:167], v[226:227] op_sel_hi:[1,0] neg_lo:[0,1] neg_hi:[0,1]
  v_pk_add_f32 v[168:169], v[168:169], v[226:227] op_sel_hi:[1,0] neg_lo:[0,1] neg_hi:[0,1]
  v_pk_add_f32 v[170:171], v[170:171], v[226:227] op_sel_hi:[1,0] neg_lo:[0,1] neg_hi:[0,1]
  v_pk_add_f32 v[172:173], v[172:173], v[226:227] op_sel_hi:[1,0] neg_lo:[0,1] neg_hi:[0,1]
  v_pk_add_f32 v[174:175], v[174:175], v[226:227] op_sel_hi:[1,0] neg_lo:[0,1] neg_hi:[0,1]
  v_pk_add_f32 v[176:177], v[176:177], v[228:229] op_sel_hi:[1,0] neg_lo:[0,1] neg_hi:[0,1]
  v_pk_add_f32 v[178:179], v[178:179], v[228:229] op_sel_hi:[1,0] neg_lo:[0,1] neg_hi:[0,1]
  v_pk_add_f32 v[180:181], v[180:181], v[228:229] op_sel_hi:[1,0] neg_lo:[0,1] neg_hi:[0,1]
  v_pk_add_f32 v[182:183], v[182:183], v[228:229] op_sel_hi:[1,0] neg_lo:[0,1] neg_hi:[0,1]
  v_pk_add_f32 v[184:185], v[184:185], v[228:229] op_sel_hi:[1,0] neg_lo:[0,1] neg_hi:[0,1]
  v_pk_add_f32 v[186:187], v[186:187], v[228:229] op_sel_hi:[1,0] neg_lo:[0,1] neg_hi:[0,1]
  v_pk_add_f32 v[188:189], v[188:189], v[228:229] op_sel_hi:[1,0] neg_lo:[0,1] neg_hi:[0,1]
  v_pk_add_f32 v[190:191], v[190:191], v[228:229] op_sel_hi:[1,0] neg_lo:[0,1] neg_hi:[0,1]
  v_pk_mul_f32 v[4:5], v[160:161], v[160:161]
  v_pk_mul_f32 v[6:7], v[176:177], v[176:177]
  v_pk_fma_f32 v[4:5], v[162:163], v[162:163], v[4:5]
  v_pk_fma_f32 v[6:7], v[178:179], v[178:179], v[6:7]
  v_pk_fma_f32 v[4:5], v[164:165], v[164:165], v[4:5]
  v_pk_fma_f32 v[6:7], v[180:181], v[180:181], v[6:7]
  v_pk_fma_f32 v[4:5], v[166:167], v[166:167], v[4:5]
  v_pk_fma_f32 v[6:7], v[182:183], v[182:183], v[6:7]
  v_pk_fma_f32 v[4:5], v[168:169], v[168:169], v[4:5]
  v_pk_fma_f32 v[6:7], v[184:185], v[184:185], v[6:7]
  v_pk_fma_f32 v[4:5], v[170:171], v[170:171], v[4:5]
  v_pk_fma_f32 v[6:7], v[186:187], v[186:187], v[6:7]
  v_pk_fma_f32 v[4:5], v[172:173], v[172:173], v[4:5]
  v_pk_fma_f32 v[6:7], v[188:189], v[188:189], v[6:7]
  v_pk_fma_f32 v[4:5], v[174:175], v[174:175], v[4:5]
  v_pk_fma_f32 v[6:7], v[190:191], v[190:191], v[6:7]
  v_add_f32 v4, v4, v5
  v_add_f32 v6, v6, v7
  s_nop 0
  v_add_f32_dpp v4, v4, v4 quad_perm:[1,0,3,2] row_mask:0xf bank_mask:0xf
  v_add_f32_dpp v6, v6, v6 quad_perm:[1,0,3,2] row_mask:0xf bank_mask:0xf
  s_nop 0
  v_add_f32_dpp v4, v4, v4 quad_perm:[2,3,0,1] row_mask:0xf bank_mask:0xf
  v_add_f32_dpp v6, v6, v6 quad_perm:[2,3,0,1] row_mask:0xf bank_mask:0xf
  s_nop 0
  v_add_f32_dpp v4, v4, v4 row_half_mirror row_mask:0xf bank_mask:0xf
  v_add_f32_dpp v6, v6, v6 row_half_mirror row_mask:0xf bank_mask:0xf
  s_nop 0
  v_add_f32_dpp v4, v4, v4 row_mirror row_mask:0xf bank_mask:0xf
  v_add_f32_dpp v6, v6, v6 row_mirror row_mask:0xf bank_mask:0xf
  v_mov_b32 v14, v4
  v_mov_b32 v15, v6
  s_nop 0
  v_permlane16_swap_b32 v14, v4
  v_permlane16_swap_b32 v15, v6
  v_add_f32 v4, v14, v4
  v_add_f32 v6, v15, v6
  v_mov_b32 v14, v4
  v_mov_b32 v15, v6
  s_nop 0
  v_permlane32_swap_b32 v14, v4
  v_permlane32_swap_b32 v15, v6
  v_add_f32 v4, v14, v4
  v_add_f32 v6, v15, v6
  v_sub_f32 v224, v224, v226
  v_mul_f32 v4, 0x3a800000, v4
  v_fma_f32 v4, -v224, v224, v4
  v_max_f32 v4, 0, v4
  v_sub_f32 v225, v225, v228
  v_mul_f32 v6, 0x3a800000, v6
  v_fma_f32 v6, -v225, v225, v6
  v_max_f32 v6, 0, v6
  v_cvt_pk_bf16_f32 v14, v4, v6
  v_lshlrev_b32 v4, 16, v14
  v_and_b32 v6, s30, v14
  v_add_f32 v4, 0x3727c5ac, v4
  v_add_f32 v6, 0x3727c5ac, v6
  v_cvt_pk_bf16_f32 v14, v4, v6
  v_lshlrev_b32 v4, 16, v14
  v_and_b32 v6, s30, v14
  v_sqrt_f32 v4, v4
  v_sqrt_f32 v6, v6
  s_nop 0
  v_cvt_pk_bf16_f32 v14, v4, v6
  v_lshlrev_b32 v4, 16, v14
  v_and_b32 v6, s30, v14
  v_rcp_f32 v232, v4
  v_rcp_f32_e64 v234, v6
  v_mul_f32_e64 v233, -v226, v232
  v_mul_f32_e64 v235, -v228, v234
  v_pk_mul_f32 v[160:161], v[160:161], v[232:233] op_sel_hi:[1,0]
  v_pk_mul_f32 v[162:163], v[162:163], v[232:233] op_sel_hi:[1,0]
  v_pk_mul_f32 v[164:165], v[164:165], v[232:233] op_sel_hi:[1,0]
  v_pk_mul_f32 v[166:167], v[166:167], v[232:233] op_sel_hi:[1,0]
  v_pk_mul_f32 v[168:169], v[168:169], v[232:233] op_sel_hi:[1,0]
  v_pk_mul_f32 v[170:171], v[170:171], v[232:233] op_sel_hi:[1,0]
  v_pk_mul_f32 v[172:173], v[172:173], v[232:233] op_sel_hi:[1,0]
  v_pk_mul_f32 v[174:175], v[174:175], v[232:233] op_sel_hi:[1,0]
  v_cvt_pk_bf16_f32 v192, v160, v161
  v_cvt_pk_bf16_f32 v193, v162, v163
  v_cvt_pk_bf16_f32 v194, v164, v165
  v_cvt_pk_bf16_f32 v195, v166, v167
  v_cvt_pk_bf16_f32 v196, v168, v169
  v_cvt_pk_bf16_f32 v197, v170, v171
  v_cvt_pk_bf16_f32 v198, v172, v173
  v_cvt_pk_bf16_f32 v199, v174, v175
  ds_write_b128 v12, v[192:195] offset:0
  ds_write_b128 v12, v[196:199] offset:1024
  v_pk_mul_f32 v[176:177], v[176:177], v[234:235] op_sel_hi:[1,0]
  v_pk_mul_f32 v[178:179], v[178:179], v[234:235] op_sel_hi:[1,0]
  v_pk_mul_f32 v[180:181], v[180:181], v[234:235] op_sel_hi:[1,0]
  v_pk_mul_f32 v[182:183], v[182:183], v[234:235] op_sel_hi:[1,0]
  v_pk_mul_f32 v[184:185], v[184:185], v[234:235] op_sel_hi:[1,0]
  v_pk_mul_f32 v[186:187], v[186:187], v[234:235] op_sel_hi:[1,0]
  v_pk_mul_f32 v[188:189], v[188:189], v[234:235] op_sel_hi:[1,0]
  v_pk_mul_f32 v[190:191], v[190:191], v[234:235] op_sel_hi:[1,0]
  v_cvt_pk_bf16_f32 v200, v176, v177
  v_cvt_pk_bf16_f32 v201, v178, v179
  v_cvt_pk_bf16_f32 v202, v180, v181
  v_cvt_pk_bf16_f32 v203, v182, v183
  v_cvt_pk_bf16_f32 v204, v184, v185
  v_cvt_pk_bf16_f32 v205, v186, v187
  v_cvt_pk_bf16_f32 v206, v188, v189
  v_cvt_pk_bf16_f32 v207, v190, v191
  ds_write_b128 v12, v[200:203] offset:2048
  ds_write_b128 v12, v[204:207] offset:3072
  ds_read_b64_tr_b16 v[208:209], v11 offset:0
  ds_read_b64_tr_b16 v[210:211], v11 offset:512
  ds_read_b64_tr_b16 v[212:213], v11 offset:1024
  ds_read_b64_tr_b16 v[214:215], v11 offset:1536
  ds_read_b64_tr_b16 v[216:217], v11 offset:2048
  ds_read_b64_tr_b16 v[218:219], v11 offset:2560
  ds_read_b64_tr_b16 v[220:221], v11 offset:3072
  ds_read_b64_tr_b16 v[222:223], v11 offset:3584
  v_mov_b32 v4, 0
  v_mov_b32 v6, 0
  s_waitcnt vmcnt(1)
  v_dot2c_f32_bf16 v4, v152, v192
  v_dot2c_f32_bf16 v6, v152, v200
  v_dot2c_f32_bf16 v4, v153, v193
  v_dot2c_f32_bf16 v6, v153, v201
  v_dot2c_f32_bf16 v4, v154, v194
  v_dot2c_f32_bf16 v6, v154, v202
  v_dot2c_f32_bf16 v4, v155, v195
  v_dot2c_f32_bf16 v6, v155, v203
  s_waitcnt vmcnt(0)
  v_dot2c_f32_bf16 v4, v156, v196
  v_dot2c_f32_bf16 v6, v156, v204
  v_dot2c_f32_bf16 v4, v157, v197
  v_dot2c_f32_bf16 v6, v157, v205
  v_dot2c_f32_bf16 v4, v158, v198
  v_dot2c_f32_bf16 v6, v158, v206
  v_dot2c_f32_bf16 v4, v159, v199
  v_dot2c_f32_bf16 v6, v159, v207
  s_waitcnt lgkmcnt(6)
  v_mfma_f32_32x32x16_bf16 v[16:31], v[208:211], v[80:83], 0
  v_mfma_f32_32x32x16_bf16 v[32:47], v[208:211], v[88:91], 0
  s_waitcnt lgkmcnt(4)
  v_mfma_f32_32x32x16_bf16 v[16:31], v[212:215], v[84:87], v[16:31]
  v_mfma_f32_32x32x16_bf16 v[32:47], v[212:215], v[92:95], v[32:47]
  s_waitcnt lgkmcnt(2)
  v_mfma_f32_32x32x16_bf16 v[16:31], v[216:219], v[96:99], v[16:31]
  v_mfma_f32_32x32x16_bf16 v[32:47], v[216:219], v[80:83], v[32:47]
  s_waitcnt lgkmcnt(0)
  v_mfma_f32_32x32x16_bf16 v[16:31], v[220:223], v[100:103], v[16:31]
  v_mfma_f32_32x32x16_bf16 v[32:47], v[220:223], v[84:87], v[32:47]
  v_add_f32_dpp v4, v4, v4 quad_perm:[1,0,3,2] row_mask:0xf bank_mask:0xf
  v_add_f32_dpp v6, v6, v6 quad_perm:[1,0,3,2] row_mask:0xf bank_mask:0xf
  s_nop 0
  v_add_f32_dpp v4, v4, v4 quad_perm:[2,3,0,1] row_mask:0xf bank_mask:0xf
  v_add_f32_dpp v6, v6, v6 quad_perm:[2,3,0,1] row_mask:0xf bank_mask:0xf
  s_nop 0
  v_add_f32_dpp v4, v4, v4 row_half_mirror row_mask:0xf bank_mask:0xf
  v_add_f32_dpp v6, v6, v6 row_half_mirror row_mask:0xf bank_mask:0xf
  s_nop 0
  v_add_f32_dpp v4, v4, v4 row_mirror row_mask:0xf bank_mask:0xf
  v_add_f32_dpp v6, v6, v6 row_mirror row_mask:0xf bank_mask:0xf
  v_mov_b32 v14, v4
  v_mov_b32 v15, v6
  s_nop 0
  v_permlane16_swap_b32 v14, v4
  v_permlane16_swap_b32 v15, v6
  v_add_f32 v4, v14, v4
  v_add_f32 v6, v15, v6
  v_mov_b32 v14, v4
  v_mov_b32 v15, v6
  s_nop 0
  v_permlane32_swap_b32 v14, v4
  v_permlane32_swap_b32 v15, v6
  v_add_f32 v4, v14, v4
  v_add_f32 v6, v15, v6
  v_cvt_pk_bf16_f32 v14, v4, v6
  v_and_b32 v4, 0xffff, v14
  v_lshrrev_b32 v6, 16, v14
  s_lshl_b32 s31, s10, 1
  s_sub_u32 s32, 2047, s31
  s_sub_u32 s33, 2046, s31
  v_bfe_i32 v14, v4, 15, 1
  v_and_b32 v14, 0x7fff, v14
  v_or_b32 v14, 0x8000, v14
  v_xor_b32 v4, v14, v4
  v_lshlrev_b32 v4, 16, v4
  v_or_b32 v4, s32, v4
  v_bfe_i32 v14, v6, 15, 1
  v_and_b32 v14, 0x7fff, v14
  v_or_b32 v14, 0x8000, v14
  v_xor_b32 v6, v14, v6
  v_lshlrev_b32 v6, 16, v6
  v_or_b32 v6, s33, v6
  v_max_u32 v4, v4, v6
  v_mov_b32_e64 v236, v4
  v_pk_mul_f32 v[160:161], v[16:17], v[104:105]
  v_pk_mul_f32 v[176:177], v[32:33], v[104:105]
  v_pk_fma_f32 v[160:161], v[32:33], v[120:121], v[160:161]
  v_pk_fma_f32 v[176:177], v[16:17], v[120:121], v[176:177] neg_lo:[1,0,0] neg_hi:[1,0,0]
  v_pk_mul_f32 v[162:163], v[18:19], v[106:107]
  v_pk_mul_f32 v[178:179], v[34:35], v[106:107]
  v_pk_fma_f32 v[162:163], v[34:35], v[122:123], v[162:163]
  v_pk_fma_f32 v[178:179], v[18:19], v[122:123], v[178:179] neg_lo:[1,0,0] neg_hi:[1,0,0]
  v_pk_mul_f32 v[164:165], v[20:21], v[108:109]
  v_pk_mul_f32 v[180:181], v[36:37], v[108:109]
  v_pk_fma_f32 v[164:165], v[36:37], v[124:125], v[164:165]
  v_pk_fma_f32 v[180:181], v[20:21], v[124:125], v[180:181] neg_lo:[1,0,0] neg_hi:[1,0,0]
  v_pk_mul_f32 v[166:167], v[22:23], v[110:111]
  v_pk_mul_f32 v[182:183], v[38:39], v[110:111]
  v_pk_fma_f32 v[166:167], v[38:39], v[126:127], v[166:167]
  v_pk_fma_f32 v[182:183], v[22:23], v[126:127], v[182:183] neg_lo:[1,0,0] neg_hi:[1,0,0]
  v_pk_mul_f32 v[168:169], v[24:25], v[112:113]
  v_pk_mul_f32 v[184:185], v[40:41], v[112:113]
  v_pk_fma_f32 v[168:169], v[40:41], v[128:129], v[168:169]
  v_pk_fma_f32 v[184:185], v[24:25], v[128:129], v[184:185] neg_lo:[1,0,0] neg_hi:[1,0,0]
  v_pk_mul_f32 v[170:171], v[26:27], v[114:115]
  v_pk_mul_f32 v[186:187], v[42:43], v[114:115]
  v_pk_fma_f32 v[170:171], v[42:43], v[130:131], v[170:171]
  v_pk_fma_f32 v[186:187], v[26:27], v[130:131], v[186:187] neg_lo:[1,0,0] neg_hi:[1,0,0]
  v_pk_mul_f32 v[172:173], v[28:29], v[116:117]
  v_pk_mul_f32 v[188:189], v[44:45], v[116:117]
  v_pk_fma_f32 v[172:173], v[44:45], v[132:133], v[172:173]
  v_pk_fma_f32 v[188:189], v[28:29], v[132:133], v[188:189] neg_lo:[1,0,0] neg_hi:[1,0,0]
  v_pk_mul_f32 v[174:175], v[30:31], v[118:119]
  v_pk_mul_f32 v[190:191], v[46:47], v[118:119]
  v_pk_fma_f32 v[174:175], v[46:47], v[134:135], v[174:175]
  v_pk_fma_f32 v[190:191], v[30:31], v[134:135], v[190:191] neg_lo:[1,0,0] neg_hi:[1,0,0]
  v_cvt_pk_bf16_f32 v192, v160, v176
  v_cvt_pk_bf16_f32 v193, v161, v177
  v_cvt_pk_bf16_f32 v194, v162, v178
  v_cvt_pk_bf16_f32 v195, v163, v179
  v_cvt_pk_bf16_f32 v196, v164, v180
  v_cvt_pk_bf16_f32 v197, v165, v181
  v_cvt_pk_bf16_f32 v198, v166, v182
  v_cvt_pk_bf16_f32 v199, v167, v183
  v_cvt_pk_bf16_f32 v200, v168, v184
  v_cvt_pk_bf16_f32 v201, v169, v185
  v_cvt_pk_bf16_f32 v202, v170, v186
  v_cvt_pk_bf16_f32 v203, v171, v187
  v_cvt_pk_bf16_f32 v204, v172, v188
  v_cvt_pk_bf16_f32 v205, v173, v189
  v_cvt_pk_bf16_f32 v206, v174, v190
  v_cvt_pk_bf16_f32 v207, v175, v191
  ds_write_b128 v8, v[192:195] offset:0
  ds_write_b128 v8, v[196:199] offset:32
  ds_write_b128 v8, v[200:203] offset:64
  ds_write_b128 v8, v[204:207] offset:96
  s_waitcnt lgkmcnt(0)
  s_barrier
  ds_read_b128 v[208:211], v9 offset:0
  ds_read_b128 v[212:215], v9 offset:32
  ds_read_b128 v[216:219], v9 offset:64
  ds_read_b128 v[220:223], v9 offset:96
  s_waitcnt lgkmcnt(3)
  v_mfma_f32_32x32x16_bf16 v[16:31], v[208:211], v[48:51], 0
  v_mfma_f32_32x32x16_bf16 v[32:47], v[208:211], v[64:67], 0
  s_waitcnt lgkmcnt(2)
  v_mfma_f32_32x32x16_bf16 v[16:31], v[212:215], v[52:55], v[16:31]
  v_mfma_f32_32x32x16_bf16 v[32:47], v[212:215], v[68:71], v[32:47]
  s_waitcnt lgkmcnt(1)
  v_mfma_f32_32x32x16_bf16 v[16:31], v[216:219], v[56:59], v[16:31]
  v_mfma_f32_32x32x16_bf16 v[32:47], v[216:219], v[72:75], v[32:47]
  s_waitcnt lgkmcnt(0)
  v_mfma_f32_32x32x16_bf16 v[16:31], v[220:223], v[60:63], v[16:31]
  v_mfma_f32_32x32x16_bf16 v[32:47], v[220:223], v[76:79], v[32:47]
  s_mul_i32 s40, s3, 262144
  s_lshl_b32 s41, s2, 7
  s_add_u32 s40, s40, s41
  s_add_u32 s41, s40, 65536
  s_add_u32 s42, s40, 131072
  s_add_u32 s43, s40, 196608
  s_nop 5
  v_cvt_pk_bf16_f32 v192, v16, v32
  v_cvt_pk_bf16_f32 v193, v17, v33
  v_cvt_pk_bf16_f32 v194, v18, v34
  v_cvt_pk_bf16_f32 v195, v19, v35
  buffer_store_dwordx4 v[192:195], v10, s[20:23], s40 offen sc0 sc1
  v_cvt_pk_bf16_f32 v196, v20, v36
  v_cvt_pk_bf16_f32 v197, v21, v37
  v_cvt_pk_bf16_f32 v198, v22, v38
  v_cvt_pk_bf16_f32 v199, v23, v39
  buffer_store_dwordx4 v[196:199], v10, s[20:23], s41 offen sc0 sc1
  v_cvt_pk_bf16_f32 v200, v24, v40
  v_cvt_pk_bf16_f32 v201, v25, v41
  v_cvt_pk_bf16_f32 v202, v26, v42
  v_cvt_pk_bf16_f32 v203, v27, v43
  buffer_store_dwordx4 v[200:203], v10, s[20:23], s42 offen sc0 sc1
  v_cvt_pk_bf16_f32 v204, v28, v44
  v_cvt_pk_bf16_f32 v205, v29, v45
  v_cvt_pk_bf16_f32 v206, v30, v46
  v_cvt_pk_bf16_f32 v207, v31, v47
  buffer_store_dwordx4 v[204:207], v10, s[20:23], s43 offen sc0 sc1
  s_lshl_b32 s34, s10, 4
  s_lshl_b32 s35, s10, 2
  s_add_u32 s35, s35, 16384
  v_mov_b32 v14, 0
  s_mov_b64 exec, 1
  buffer_store_dwordx4 v[232:235], v14, s[24:27], s34 offen
  buffer_store_dword v236, v14, s[24:27], s35 offen
  s_endpgm
K1_PRE:
  s_load_dwordx2 s[4:5], s[0:1], 8
  s_load_dwordx2 s[6:7], s[0:1], 16
  s_load_dwordx2 s[8:9], s[0:1], 80
  s_sub_u32 s3, s2, 256
  s_lshr_b32 s11, s3, 3
  s_and_b32 s11, s11, 7
  s_lshr_b32 s10, s3, 6
  s_lshl_b32 s10, s10, 3
  s_and_b32 s12, s3, 7
  s_add_u32 s10, s10, s12
  s_and_b32 s28, s10, 3
  s_lshr_b32 s10, s10, 2
  v_lshrrev_b32 v1, 6, v0
  s_nop 0
  v_readfirstlane_b32 s29, v1
  v_and_b32 v1, 7, v0
  v_lshrrev_b32 v2, 3, v0
  v_lshrrev_b32 v3, 2, v2
  v_and_b32 v4, 3, v2
  v_lshlrev_b32 v4, 5, v4
  v_add_u32 v3, v3, v4
  v_mul_u32_u24 v3, 1026, v3
  v_lshlrev_b32 v4, 4, v1
  v_add_u32 v3, v3, v4
  s_lshl_b32 s12, s10, 7
  s_lshl_b32 s13, s28, 3
  s_add_u32 s12, s12, s13
  s_mul_i32 s12, s12, 1026
  s_lshl_b32 s13, s11, 7
  s_add_u32 s12, s12, s13
  s_add_u32 s14, s12, 1050624
  s_waitcnt lgkmcnt(0)
  s_mov_b32 s16, s4
  s_mov_b32 s17, s5
  s_mov_b32 s18, 0x201000
  s_mov_b32 s19, 0x20000
  s_mov_b32 s20, s6
  s_mov_b32 s21, s7
  s_mov_b32 s22, 0x201000
  s_mov_b32 s23, 0x20000
  s_add_u32 s24, s8, 0x800000
  s_addc_u32 s25, s9, 0
  s_mov_b32 s26, 0x402000
  s_mov_b32 s27, 0x20000
  buffer_load_dwordx4 v[8:11], v3, s[16:19], s12 offen nt
  buffer_load_dwordx4 v[16:19], v3, s[20:23], s12 offen nt
  buffer_load_dwordx4 v[12:15], v3, s[16:19], s14 offen nt
  buffer_load_dwordx4 v[20:23], v3, s[20:23], s14 offen nt
  v_and_b32 v88, 7, v0
  v_lshrrev_b32 v89, 2, v88
  s_lshl_b32 s30, s29, 1
  v_add_u32 v89, s30, v89
  v_lshrrev_b32 v90, 2, v89
  v_and_b32 v91, 3, v89
  v_lshlrev_b32 v91, 5, v91
  v_add_u32 v90, v90, v91
  s_and_b32 s30, s3, 127
  s_lshr_b32 s31, s30, 4
  s_lshl_b32 s31, s31, 7
  s_and_b32 s30, s30, 15
  s_lshl_b32 s32, s30, 1
  s_add_u32 s31, s31, s32
  v_add_u32 v90, s31, v90
  s_lshr_b32 s33, s3, 7
  s_lshl_b32 s34, s33, 10
  v_and_b32 v88, 3, v88
  v_and_b32 v91, 1, v88
  v_lshlrev_b32 v91, 10, v91
  v_add_u32 v92, v90, v91
  v_sub_u32 v93, 2048, v91
  v_sub_u32 v93, v93, v90
  v_and_b32 v93, 2047, v93
  v_cmp_gt_u32 vcc, 2, v88
  s_nop 1
  v_cndmask_b32 v92, v93, v92, vcc
  v_mul_u32_u24 v92, 1026, v92
  s_mov_b64 exec, 0xff
  buffer_load_ushort v96, v92, s[16:19], s34 offen
  buffer_load_ushort v97, v92, s[20:23], s34 offen
  s_mov_b64 exec, -1
  s_add_u32 s36, s8, 0xd00000
  s_addc_u32 s37, s9, 0
  s_mov_b32 s38, 0x104000
  s_mov_b32 s39, 0x20000
  s_cmp_lt_u32 s3, 252
  s_cselect_b32 s40, -1, 0
  v_mov_b32 v120, s40
  v_mov_b32 v121, s40
  v_mov_b32 v122, s40
  v_mov_b32 v123, s40
  v_lshlrev_b32 v124, 4, v0
  s_lshl_b32 s41, s3, 12
  buffer_store_dwordx4 v[120:123], v124, s[36:39], s41 offen sc0 sc1
  v_mov_b32 v128, 0
  v_mov_b32 v129, 0
  v_mov_b32 v130, 0
  v_mov_b32 v131, 0
  s_add_u32 s41, s41, 1048576
  buffer_store_dwordx4 v[128:131], v124, s[36:39], s41 offen sc0 sc1
  s_cmp_lt_u32 s3, 8
  s_cbranch_scc0 K1_PRE_NOCODE
  v_lshlrev_b32 v116, 6, v0
  s_getpc_b64 s[44:45]
K1_CP:
  s_add_u32 s44, s44, fft_k23_kernel-K1_CP
  s_addc_u32 s45, s45, 0
  s_mov_b32 s46, CODE_END-fft_k23_kernel
  s_mov_b32 s47, 0x20000
  s_movk_i32 s48, 16384
  buffer_load_dword v117, v116, s[44:47], 0 offen
  buffer_load_dword v117, v116, s[44:47], s48 offen
  s_waitcnt vmcnt(0)
K1_PRE_NOCODE:
  v_mul_u32_u24 v5, 2176, v1
  v_lshlrev_b32 v6, 2, v1
  v_add_u32 v6, v6, v2
  v_and_b32 v6, 31, v6
  v_lshl_add_u32 v6, v6, 2, v5
  s_mov_b32 s30, 0xffff0000
  s_waitcnt vmcnt(7)
  v_lshlrev_b32 v48, 16, v8
  v_and_b32 v49, s30, v8
  s_waitcnt vmcnt(5)
  v_lshlrev_b32 v50, 16, v12
  v_and_b32 v51, s30, v12
  v_lshlrev_b32 v52, 16, v16
  v_and_b32 v53, s30, v16
  s_waitcnt vmcnt(4)
  v_lshlrev_b32 v54, 16, v20
  v_and_b32 v55, s30, v20
  v_pk_add_f32 v[56:57], v[48:49], v[50:51]
  v_pk_add_f32 v[58:59], v[52:53], v[54:55]
  v_pk_add_f32 v[60:61], v[48:49], v[50:51] neg_lo:[0,1] neg_hi:[0,1]
  v_pk_add_f32 v[62:63], v[52:53], v[54:55] neg_lo:[0,1] neg_hi:[0,1]
  v_cvt_pk_bf16_f32 v64, v56, v58
  v_cvt_pk_bf16_f32 v65, v60, v62
  v_cvt_pk_bf16_f32 v66, v57, v59
  v_cvt_pk_bf16_f32 v67, v61, v63
  ds_write_b32 v6, v64 offset:0
  ds_write_b32 v6, v65 offset:128
  ds_write_b32 v6, v66 offset:272
  ds_write_b32 v6, v67 offset:400
  v_lshlrev_b32 v48, 16, v9
  v_and_b32 v49, s30, v9
  v_lshlrev_b32 v50, 16, v13
  v_and_b32 v51, s30, v13
  v_lshlrev_b32 v52, 16, v17
  v_and_b32 v53, s30, v17
  v_lshlrev_b32 v54, 16, v21
  v_and_b32 v55, s30, v21
  v_pk_add_f32 v[56:57], v[48:49], v[50:51]
  v_pk_add_f32 v[58:59], v[52:53], v[54:55]
  v_pk_add_f32 v[60:61], v[48:49], v[50:51] neg_lo:[0,1] neg_hi:[0,1]
  v_pk_add_f32 v[62:63], v[52:53], v[54:55] neg_lo:[0,1] neg_hi:[0,1]
  v_cvt_pk_bf16_f32 v68, v56, v58
  v_cvt_pk_bf16_f32 v69, v60, v62
  v_cvt_pk_bf16_f32 v70, v57, v59
  v_cvt_pk_bf16_f32 v71, v61, v63
  ds_write_b32 v6, v68 offset:544
  ds_write_b32 v6, v69 offset:672
  ds_write_b32 v6, v70 offset:816
  ds_write_b32 v6, v71 offset:944
  v_lshlrev_b32 v48, 16, v10
  v_and_b32 v49, s30, v10
  v_lshlrev_b32 v50, 16, v14
  v_and_b32 v51, s30, v14
  v_lshlrev_b32 v52, 16, v18
  v_and_b32 v53, s30, v18
  v_lshlrev_b32 v54, 16, v22
  v_and_b32 v55, s30, v22
  v_pk_add_f32 v[56:57], v[48:49], v[50:51]
  v_pk_add_f32 v[58:59], v[52:53], v[54:55]
  v_pk_add_f32 v[60:61], v[48:49], v[50:51] neg_lo:[0,1] neg_hi:[0,1]
  v_pk_add_f32 v[62:63], v[52:53], v[54:55] neg_lo:[0,1] neg_hi:[0,1]
  v_cvt_pk_bf16_f32 v64, v56, v58
  v_cvt_pk_bf16_f32 v65, v60, v62
  v_cvt_pk_bf16_f32 v66, v57, v59
  v_cvt_pk_bf16_f32 v67, v61, v63
  ds_write_b32 v6, v64 offset:1088
  ds_write_b32 v6, v65 offset:1216
  ds_write_b32 v6, v66 offset:1360
  ds_write_b32 v6, v67 offset:1488
  v_lshlrev_b32 v48, 16, v11
  v_and_b32 v49, s30, v11
  v_lshlrev_b32 v50, 16, v15
  v_and_b32 v51, s30, v15
  v_lshlrev_b32 v52, 16, v19
  v_and_b32 v53, s30, v19
  v_lshlrev_b32 v54, 16, v23
  v_and_b32 v55, s30, v23
  v_pk_add_f32 v[56:57], v[48:49], v[50:51]
  v_pk_add_f32 v[58:59], v[52:53], v[54:55]
  v_pk_add_f32 v[60:61], v[48:49], v[50:51] neg_lo:[0,1] neg_hi:[0,1]
  v_pk_add_f32 v[62:63], v[52:53], v[54:55] neg_lo:[0,1] neg_hi:[0,1]
  v_cvt_pk_bf16_f32 v68, v56, v58
  v_cvt_pk_bf16_f32 v69, v60, v62
  v_cvt_pk_bf16_f32 v70, v57, v59
  v_cvt_pk_bf16_f32 v71, v61, v63
  ds_write_b32 v6, v68 offset:1632
  ds_write_b32 v6, v69 offset:1760
  ds_write_b32 v6, v70 offset:1904
  ds_write_b32 v6, v71 offset:2032
  s_waitcnt lgkmcnt(0)
  s_barrier
  v_lshrrev_b32 v1, 4, v0
  v_bfe_u32 v2, v0, 3, 1
  v_and_b32 v3, 7, v0
  v_mul_u32_u24 v4, 272, v1
  v_lshlrev_b32 v5, 7, v2
  v_add_u32 v4, v4, v5
  v_lshrrev_b32 v5, 7, v0
  v_add_u32 v5, v5, v3
  v_add_u32 v72, 0, v5
  v_and_b32 v72, 7, v72
  v_lshl_add_u32 v72, v72, 4, v4
  v_add_u32 v73, 2, v5
  v_and_b32 v73, 7, v73
  v_lshl_add_u32 v73, v73, 4, v4
  v_add_u32 v74, 4, v5
  v_and_b32 v74, 7, v74
  v_lshl_add_u32 v74, v74, 4, v4
  v_add_u32 v75, 6, v5
  v_and_b32 v75, 7, v75
  v_lshl_add_u32 v75, v75, 4, v4
  v_lshlrev_b32 v7, 13, v1
  v_lshlrev_b32 v5, 10, v2
  v_lshlrev_b32 v6, 4, v3
  v_add3_u32 v7, v7, v5, v6
  ds_read_b128 v[8:11], v72 offset:0
  ds_read_b128 v[12:15], v73 offset:4352
  ds_read_b128 v[16:19], v74 offset:8704
  ds_read_b128 v[20:23], v75 offset:13056
  s_lshl_b32 s12, s11, 19
  s_lshr_b32 s13, s10, 1
  s_lshl_b32 s13, s13, 11
  s_add_u32 s12, s12, s13
  s_and_b32 s13, s10, 1
  s_lshl_b32 s13, s13, 9
  s_add_u32 s12, s12, s13
  s_lshl_b32 s13, s28, 7
  s_add_u32 s12, s12, s13
  s_cmp_eq_u32 s11, 0
  s_cselect_b32 s14, 16, 0
  v_mov_b32 v5, 0x7ff00000
  v_cmp_gt_u32 vcc, s14, v0
  s_nop 1
  v_cndmask_b32 v6, v7, v5, vcc
  s_waitcnt lgkmcnt(3)
  buffer_store_dwordx4 v[8:11], v6, s[24:27], s12 offen sc0 sc1
  s_add_u32 s12, s12, 131072
  s_waitcnt lgkmcnt(2)
  buffer_store_dwordx4 v[12:15], v7, s[24:27], s12 offen sc0 sc1
  s_add_u32 s12, s12, 131072
  s_waitcnt lgkmcnt(1)
  buffer_store_dwordx4 v[16:19], v7, s[24:27], s12 offen sc0 sc1
  s_add_u32 s12, s12, 131072
  s_waitcnt lgkmcnt(0)
  buffer_store_dwordx4 v[20:23], v7, s[24:27], s12 offen sc0 sc1
  s_waitcnt vmcnt(7)
  v_lshlrev_b32 v96, 16, v96
  s_waitcnt vmcnt(6)
  v_lshlrev_b32 v97, 16, v97
  v_mov_b32_dpp v98, v96 quad_perm:[0,0,0,0] row_mask:0xf bank_mask:0xf
  s_nop 0
  v_mov_b32_dpp v102, v97 quad_perm:[0,0,0,0] row_mask:0xf bank_mask:0xf
  v_mov_b32_dpp v99, v96 quad_perm:[1,1,1,1] row_mask:0xf bank_mask:0xf
  v_mov_b32_dpp v103, v97 quad_perm:[1,1,1,1] row_mask:0xf bank_mask:0xf
  v_mov_b32_dpp v100, v96 quad_perm:[2,2,2,2] row_mask:0xf bank_mask:0xf
  v_mov_b32_dpp v104, v97 quad_perm:[2,2,2,2] row_mask:0xf bank_mask:0xf
  v_mov_b32_dpp v101, v96 quad_perm:[3,3,3,3] row_mask:0xf bank_mask:0xf
  v_mov_b32_dpp v105, v97 quad_perm:[3,3,3,3] row_mask:0xf bank_mask:0xf
  v_add_f32 v106, v98, v100
  v_sub_f32 v107, v102, v104
  v_add_f32 v108, v99, v101
  v_sub_f32 v109, v103, v105
  v_add_f32 v110, v106, v108
  v_add_f32 v111, v107, v109
  v_sub_f32 v112, v106, v108
  v_sub_f32 v113, v107, v109
  v_mul_f32 v110, 0.5, v110
  v_mul_f32 v111, 0.5, v111
  v_mul_f32 v112, 0.5, v112
  v_mul_f32 v113, 0.5, v113
  v_cvt_pk_bf16_f32 v106, v110, v111
  v_cvt_pk_bf16_f32 v107, v112, v113
  v_cmp_eq_u32 vcc, 0, v88
  s_nop 1
  v_cndmask_b32 v106, v107, v106, vcc
  s_and_b32 s30, s3, 127
  s_lshr_b32 s31, s30, 4
  s_and_b32 s30, s30, 15
  s_lshr_b32 s32, s31, 1
  s_lshl_b32 s32, s32, 11
  s_and_b32 s31, s31, 1
  s_lshl_b32 s31, s31, 9
  s_add_u32 s32, s32, s31
  s_lshl_b32 s30, s30, 5
  s_add_u32 s32, s32, s30
  s_lshl_b32 s33, s33, 22
  s_add_u32 s32, s32, s33
  v_lshlrev_b32 v89, 2, v89
  v_lshl_add_u32 v89, v88, 10, v89
  s_mov_b64 exec, 0x33
  buffer_store_dword v106, v89, s[24:27], s32 offen
  s_endpgm
.globl fft_k23_kernel
.p2align 8
.type fft_k23_kernel,@function
fft_k23_kernel:
  s_cmp_lt_u32 s2, 256
  s_cbranch_scc1 K23_F
  s_cmp_lt_u32 s2, 480
  s_cbranch_scc1 K23_M
  s_cmp_lt_u32 s2, 512
  s_cbranch_scc1 K23_S
  s_endpgm
K23_F:
  s_setprio 3
  s_load_dwordx2 s[8:9], s[0:1], 80
  s_load_dwordx2 s[4:5], s[0:1], 0
  s_load_dwordx2 s[6:7], s[0:1], 64
  v_lshrrev_b32 v3, 6, v0
  v_and_b32 v1, 63, v0
  v_readfirstlane_b32 s3, v3
  v_lshlrev_b32 v2, 4, v1
  s_lshr_b32 s11, s2, 4
  s_lshl_b32 s11, s11, 3
  s_and_b32 s12, s2, 7
  s_add_u32 s10, s11, s12
  s_lshr_b32 s11, s10, 5
  s_sub_u32 s11, 7, s11
  s_lshl_b32 s11, s11, 5
  s_and_b32 s12, s10, 31
  s_sub_u32 s12, 32, s12
  s_and_b32 s12, s12, 31
  s_add_u32 s11, s11, s12
  s_bitcmp1_b32 s2, 3
  s_cselect_b32 s10, s11, s10
  s_lshr_b32 s11, s10, 5
  s_and_b32 s12, s10, 31
  s_sub_u32 s13, 7, s11
  s_lshl_b32 s13, s13, 5
  s_sub_u32 s14, 32, s12
  s_and_b32 s14, s14, 31
  s_add_u32 s13, s13, s14
  s_waitcnt lgkmcnt(0)
  s_add_u32 s20, s8, 0x1000000
  s_addc_u32 s21, s9, 0
  s_mov_b32 s22, 0x400000
  s_mov_b32 s23, 0x20000
  s_or_b32 s15, s12, s3
  s_cmp_eq_u32 s15, 0
  s_cselect_b32 s16, 1, 0
  s_and_b32 s17, s11, 3
  s_cmp_lg_u32 s17, 0
  s_cselect_b32 s17, s16, 0
  s_cmp_eq_u32 s17, 0
  s_cbranch_scc1 K2_NOSPEC
  s_sub_u32 s19, 8, s11
  s_and_b32 s19, s19, 7
  s_lshl_b32 s19, s19, 5
  s_lshr_b32 s18, s19, 6
  s_lshl_b32 s18, s18, 5
  s_and_b32 s45, s19, 31
  s_add_u32 s18, s18, s45
  s_mul_i32 s18, s18, 32768
  s_bfe_u32 s45, s19, 0x10005
  s_lshl_b32 s45, s45, 6
  s_add_u32 s18, s18, s45
  v_mul_u32_u24 v4, 128, v1
  v_bfe_u32 v5, v1, 2, 2
  v_lshlrev_b32 v5, 4, v5
  v_add_u32 v4, v4, v5
  buffer_load_dwordx4 v[208:211], v4, s[20:23], s18 offen
  s_add_u32 s18, s18, 8192
  buffer_load_dwordx4 v[212:215], v4, s[20:23], s18 offen
  s_add_u32 s18, s18, 8192
  buffer_load_dwordx4 v[216:219], v4, s[20:23], s18 offen
  s_add_u32 s18, s18, 8192
  buffer_load_dwordx4 v[220:223], v4, s[20:23], s18 offen
K2_NOSPEC:
  s_lshl_b32 s24, s11, 7
  s_lshl_b32 s25, s3, 5
  s_add_u32 s24, s24, s25
  s_add_u32 s24, s24, s12
  s_sub_u32 s25, 1024, s24
  s_cmp_lt_u32 s11, 4
  s_cselect_b32 s26, s24, s25
  s_cselect_b32 s27, 1, 0
  s_add_u32 s28, s8, 0x800000
  s_addc_u32 s29, s9, 0
  s_mov_b32 s30, 0x402000
  s_mov_b32 s31, 0x20000
  s_lshl_b32 s32, s26, 13
  s_add_u32 s33, s32, 4096
  buffer_load_dwordx4 v[176:179], v2, s[28:31], s32 offen offset:0
  buffer_load_dwordx4 v[192:195], v2, s[28:31], s32 offen offset:1024
  buffer_load_dwordx4 v[180:183], v2, s[28:31], s32 offen offset:2048
  buffer_load_dwordx4 v[196:199], v2, s[28:31], s32 offen offset:3072
  buffer_load_dwordx4 v[184:187], v2, s[28:31], s33 offen offset:0
  buffer_load_dwordx4 v[200:203], v2, s[28:31], s33 offen offset:1024
  buffer_load_dwordx4 v[188:191], v2, s[28:31], s33 offen offset:2048
  buffer_load_dwordx4 v[204:207], v2, s[28:31], s33 offen offset:3072
  v_lshrrev_b32 v13, 2, v1
  v_lshlrev_b32 v13, 7, v13
  v_and_b32 v4, 3, v1
  v_lshl_add_u32 v13, v4, 4, v13
  s_lshr_b32 s19, s10, 6
  s_lshl_b32 s19, s19, 5
  s_and_b32 s18, s10, 31
  s_add_u32 s19, s19, s18
  s_mul_i32 s19, s19, 32768
  s_bfe_u32 s18, s10, 0x10005
  s_lshl_b32 s18, s18, 6
  s_add_u32 s19, s19, s18
  s_lshl_b32 s18, s3, 13
  s_add_u32 s19, s19, s18
  s_lshl_b32 s18, s3, 12
  s_add_u32 m0, s18, 0
  s_nop 0
  buffer_load_dwordx4 v13, s[20:23], s19 offen lds
  s_add_u32 m0, s18, 1024
  s_add_u32 s19, s19, 2048
  buffer_load_dwordx4 v13, s[20:23], s19 offen lds
  s_add_u32 m0, s18, 2048
  s_add_u32 s19, s19, 2048
  buffer_load_dwordx4 v13, s[20:23], s19 offen lds
  s_add_u32 m0, s18, 3072
  s_add_u32 s19, s19, 2048
  buffer_load_dwordx4 v13, s[20:23], s19 offen lds
  s_lshr_b32 s19, s13, 6
  s_lshl_b32 s19, s19, 5
  s_and_b32 s18, s13, 31
  s_add_u32 s19, s19, s18
  s_mul_i32 s19, s19, 32768
  s_bfe_u32 s18, s13, 0x10005
  s_lshl_b32 s18, s18, 6
  s_add_u32 s19, s19, s18
  s_lshl_b32 s18, s3, 13
  s_add_u32 s19, s19, s18
  s_lshl_b32 s18, s3, 12
  s_add_u32 m0, s18, 16384
  s_nop 0
  buffer_load_dwordx4 v13, s[20:23], s19 offen lds
  s_add_u32 m0, s18, 17408
  s_add_u32 s19, s19, 2048
  buffer_load_dwordx4 v13, s[20:23], s19 offen lds
  s_add_u32 m0, s18, 18432
  s_add_u32 s19, s19, 2048
  buffer_load_dwordx4 v13, s[20:23], s19 offen lds
  s_add_u32 m0, s18, 19456
  s_add_u32 s19, s19, 2048
  buffer_load_dwordx4 v13, s[20:23], s19 offen lds
  s_add_u32 s36, s8, 0x1800000
  s_addc_u32 s37, s9, 0
  s_mov_b32 s38, 0x400000
  s_mov_b32 s39, 0x20000
  v_and_b32 v4, 31, v1
  v_cvt_f32_u32 v4, v4
  v_lshrrev_b32 v5, 5, v1
  v_cvt_f32_u32 v5, v5
  v_mul_f32 v4, 0x3d000000, v4
  v_mul_f32 v5, 4.0, v5
  v_mul_f32 v5, v4, v5
  v_fmamk_f32 v32, v4, 0x00000000, v5
  v_fmamk_f32 v33, v4, 0x3f800000, v5
  v_fmamk_f32 v34, v4, 0x40000000, v5
  v_fmamk_f32 v35, v4, 0x40400000, v5
  v_fmamk_f32 v36, v4, 0x41000000, v5
  v_fmamk_f32 v37, v4, 0x41100000, v5
  v_fmamk_f32 v38, v4, 0x41200000, v5
  v_fmamk_f32 v39, v4, 0x41300000, v5
  v_fmamk_f32 v40, v4, 0x41800000, v5
  v_fmamk_f32 v41, v4, 0x41880000, v5
  v_fmamk_f32 v42, v4, 0x41900000, v5
  v_fmamk_f32 v43, v4, 0x41980000, v5
  v_fmamk_f32 v44, v4, 0x41c00000, v5
  v_fmamk_f32 v45, v4, 0x41c80000, v5
  v_fmamk_f32 v46, v4, 0x41d00000, v5
  v_fmamk_f32 v47, v4, 0x41d80000, v5
  v_mul_f32 v96, 0x3d000000, v32
  v_mul_f32 v97, 0x3d000000, v33
  v_mul_f32 v98, 0x3d000000, v34
  v_mul_f32 v99, 0x3d000000, v35
  v_mul_f32 v100, 0x3d000000, v36
  v_mul_f32 v101, 0x3d000000, v37
  v_mul_f32 v102, 0x3d000000, v38
  v_mul_f32 v103, 0x3d000000, v39
  v_mul_f32 v104, 0x3d000000, v40
  v_mul_f32 v105, 0x3d000000, v41
  v_mul_f32 v106, 0x3d000000, v42
  v_mul_f32 v107, 0x3d000000, v43
  v_mul_f32 v108, 0x3d000000, v44
  v_mul_f32 v109, 0x3d000000, v45
  v_mul_f32 v110, 0x3d000000, v46
  v_mul_f32 v111, 0x3d000000, v47
  v_cos_f32 v80, v96
  v_cos_f32 v81, v97
  v_cos_f32 v82, v98
  v_cos_f32 v83, v99
  v_cos_f32 v84, v100
  v_cos_f32 v85, v101
  v_cos_f32 v86, v102
  v_cos_f32 v87, v103
  v_cos_f32 v88, v104
  v_cos_f32 v89, v105
  v_cos_f32 v90, v106
  v_cos_f32 v91, v107
  v_cos_f32 v92, v108
  v_cos_f32 v93, v109
  v_cos_f32 v94, v110
  v_cos_f32 v95, v111
  v_sin_f32 v96, v96
  v_sin_f32 v97, v97
  v_sin_f32 v98, v98
  v_sin_f32 v99, v99
  v_sin_f32 v100, v100
  v_sin_f32 v101, v101
  v_sin_f32 v102, v102
  v_sin_f32 v103, v103
  v_sin_f32 v104, v104
  v_sin_f32 v105, v105
  v_sin_f32 v106, v106
  v_sin_f32 v107, v107
  v_sin_f32 v108, v108
  v_sin_f32 v109, v109
  v_sin_f32 v110, v110
  v_sin_f32 v111, v111
  v_cos_f32 v16, v32
  v_cos_f32 v17, v33
  v_cos_f32 v18, v34
  v_cos_f32 v19, v35
  v_cos_f32 v20, v36
  v_cos_f32 v21, v37
  v_cos_f32 v22, v38
  v_cos_f32 v23, v39
  v_cos_f32 v24, v40
  v_cos_f32 v25, v41
  v_cos_f32 v26, v42
  v_cos_f32 v27, v43
  v_cos_f32 v28, v44
  v_cos_f32 v29, v45
  v_cos_f32 v30, v46
  v_cos_f32 v31, v47
  v_sin_f32 v32, v32
  v_sin_f32 v33, v33
  v_sin_f32 v34, v34
  v_sin_f32 v35, v35
  v_sin_f32 v36, v36
  v_sin_f32 v37, v37
  v_sin_f32 v38, v38
  v_sin_f32 v39, v39
  v_sin_f32 v40, v40
  v_sin_f32 v41, v41
  v_sin_f32 v42, v42
  v_sin_f32 v43, v43
  v_sin_f32 v44, v44
  v_sin_f32 v45, v45
  v_sin_f32 v46, v46
  v_sin_f32 v47, v47
  v_cvt_pk_bf16_f32 v48, v16, v32
  v_cvt_pk_bf16_f32 v49, v17, v33
  v_cvt_pk_bf16_f32 v50, v18, v34
  v_cvt_pk_bf16_f32 v51, v19, v35
  v_cvt_pk_bf16_f32 v52, v20, v36
  v_cvt_pk_bf16_f32 v53, v21, v37
  v_cvt_pk_bf16_f32 v54, v22, v38
  v_cvt_pk_bf16_f32 v55, v23, v39
  v_cvt_pk_bf16_f32 v56, v24, v40
  v_cvt_pk_bf16_f32 v57, v25, v41
  v_cvt_pk_bf16_f32 v58, v26, v42
  v_cvt_pk_bf16_f32 v59, v27, v43
  v_cvt_pk_bf16_f32 v60, v28, v44
  v_cvt_pk_bf16_f32 v61, v29, v45
  v_cvt_pk_bf16_f32 v62, v30, v46
  v_cvt_pk_bf16_f32 v63, v31, v47
  v_cvt_pk_bf16_f32 v64, -v32, v16
  v_cvt_pk_bf16_f32 v65, -v33, v17
  v_cvt_pk_bf16_f32 v66, -v34, v18
  v_cvt_pk_bf16_f32 v67, -v35, v19
  v_cvt_pk_bf16_f32 v68, -v36, v20
  v_cvt_pk_bf16_f32 v69, -v37, v21
  v_cvt_pk_bf16_f32 v70, -v38, v22
  v_cvt_pk_bf16_f32 v71, -v39, v23
  v_cvt_pk_bf16_f32 v72, -v40, v24
  v_cvt_pk_bf16_f32 v73, -v41, v25
  v_cvt_pk_bf16_f32 v74, -v42, v26
  v_cvt_pk_bf16_f32 v75, -v43, v27
  v_cvt_pk_bf16_f32 v76, -v44, v28
  v_cvt_pk_bf16_f32 v77, -v45, v29
  v_cvt_pk_bf16_f32 v78, -v46, v30
  v_cvt_pk_bf16_f32 v79, -v47, v31
  v_and_b32 v4, 31, v1
  v_lshrrev_b32 v5, 5, v1
  v_lshlrev_b32 v5, 7, v5
  v_add_u32 v4, v4, v5
  v_cvt_f32_u32 v4, v4
  s_cmp_eq_u32 s27, 1
  s_cselect_b32 s34, 0, 0x3f000000
  v_mov_b32 v5, s34
  v_fmac_f32 v5, 0x3a000000, v4
  v_add_f32 v112, 0x00000000, v5
  v_add_f32 v113, 0x3c800000, v5
  v_add_f32 v114, 0x3d000000, v5
  v_add_f32 v115, 0x3d400000, v5
  v_add_f32 v116, 0x3e000000, v5
  v_add_f32 v117, 0x3e100000, v5
  v_add_f32 v118, 0x3e200000, v5
  v_add_f32 v119, 0x3e300000, v5
  v_add_f32 v120, 0x3e800000, v5
  v_add_f32 v121, 0x3e880000, v5
  v_add_f32 v122, 0x3e900000, v5
  v_add_f32 v123, 0x3e980000, v5
  v_add_f32 v124, 0x3ec00000, v5
  v_add_f32 v125, 0x3ec80000, v5
  v_add_f32 v126, 0x3ed00000, v5
  v_add_f32 v127, 0x3ed80000, v5
  v_cos_f32 v128, v112
  v_cos_f32 v129, v113
  v_cos_f32 v130, v114
  v_cos_f32 v131, v115
  v_cos_f32 v132, v116
  v_cos_f32 v133, v117
  v_cos_f32 v134, v118
  v_cos_f32 v135, v119
  v_cos_f32 v136, v120
  v_cos_f32 v137, v121
  v_cos_f32 v138, v122
  v_cos_f32 v139, v123
  v_cos_f32 v140, v124
  v_cos_f32 v141, v125
  v_cos_f32 v142, v126
  v_cos_f32 v143, v127
  v_sin_f32 v112, v112
  v_sin_f32 v113, v113
  v_sin_f32 v114, v114
  v_sin_f32 v115, v115
  v_sin_f32 v116, v116
  v_sin_f32 v117, v117
  v_sin_f32 v118, v118
  v_sin_f32 v119, v119
  v_sin_f32 v120, v120
  v_sin_f32 v121, v121
  v_sin_f32 v122, v122
  v_sin_f32 v123, v123
  v_sin_f32 v124, v124
  v_sin_f32 v125, v125
  v_sin_f32 v126, v126
  v_sin_f32 v127, v127
  v_and_b32 v4, 31, v1
  v_lshrrev_b32 v5, 5, v1
  v_lshlrev_b32 v5, 4, v5
  v_mul_u32_u24 v8, 144, v4
  v_add_u32 v8, v5, v8
  s_mul_i32 s40, s3, 4672
  s_add_u32 s40, s40, 32768
  v_add_u32 v8, s40, v8
  v_and_b32 v9, 3, v4
  v_mul_u32_u24 v9, 4672, v9
  v_lshrrev_b32 v4, 2, v4
  v_mul_u32_u24 v4, 144, v4
  v_add3_u32 v9, v9, v4, v5
  s_mul_i32 s40, s3, 1152
  s_add_u32 s40, s40, 32768
  v_add_u32 v9, s40, v9
  v_and_b32 v4, 31, v1
  v_lshrrev_b32 v10, 3, v4
  v_lshlrev_b32 v10, 5, v10
  v_lshrrev_b32 v5, 5, v1
  v_add_u32 v10, v5, v10
  v_mul_u32_u24 v10, 32768, v10
  v_bfe_u32 v5, v4, 2, 1
  v_lshl_add_u32 v10, v5, 6, v10
  s_lshr_b32 s40, s10, 2
  s_and_b32 s40, s40, 3
  v_and_b32 v4, 3, v4
  v_xor_b32 v4, s40, v4
  v_lshlrev_b32 v4, 4, v4
  v_add_u32 v10, v4, v10
  v_bfe_u32 v4, v1, 2, 2
  v_lshlrev_b32 v5, 6, v1
  v_xor_b32 v6, s3, v4
  v_lshlrev_b32 v6, 4, v6
  v_add_u32 v11, v5, v6
  s_sub_u32 s34, 3, s3
  s_sub_u32 s35, 4, s3
  s_and_b32 s35, s35, 3
  s_cmp_eq_u32 s12, 0
  s_cselect_b32 s34, s35, s34
  s_cmp_eq_u32 s16, 1
  s_cselect_b32 s35, 0, 16384
  v_xor_b32 v6, s34, v4
  v_lshlrev_b32 v6, 4, v6
  v_add3_u32 v12, v5, v6, s35
  s_mov_b32 s34, 0xffff0000
  s_waitcnt vmcnt(14)
  v_lshlrev_b32 v244, 16, v192
  v_and_b32 v246, s34, v192
  v_lshlrev_b32 v240, 16, v176
  v_and_b32 v242, s34, v176
  v_lshlrev_b32 v245, 16, v193
  v_and_b32 v247, s34, v193
  v_lshlrev_b32 v241, 16, v177
  v_and_b32_e64 v243, s34, v177
  v_pk_mul_f32 v[192:193], v[128:129], v[246:247]
  v_pk_fma_f32 v[176:177], v[112:113], v[246:247], v[242:243] neg_lo:[1,0,0] neg_hi:[1,0,0]
  v_pk_mul_f32 v[128:129], v[128:129], v[244:245]
  v_pk_fma_f32 v[112:113], v[112:113], v[244:245], v[240:241] neg_lo:[1,0,0] neg_hi:[1,0,0]
  v_lshlrev_b32 v252, 16, v194
  v_and_b32 v254, s34, v194
  v_lshlrev_b32 v248, 16, v178
  v_and_b32 v250, s34, v178
  v_lshlrev_b32 v253, 16, v195
  v_and_b32 v255, s34, v195
  v_lshlrev_b32 v249, 16, v179
  v_and_b32 v251, s34, v179
  v_pk_mul_f32 v[194:195], v[130:131], v[254:255]
  v_pk_fma_f32 v[178:179], v[114:115], v[254:255], v[250:251] neg_lo:[1,0,0] neg_hi:[1,0,0]
  v_pk_mul_f32 v[130:131], v[130:131], v[252:253]
  v_pk_fma_f32 v[114:115], v[114:115], v[252:253], v[248:249] neg_lo:[1,0,0] neg_hi:[1,0,0]
  s_waitcnt vmcnt(12)
  v_lshlrev_b32 v244, 16, v196
  v_and_b32 v246, s34, v196
  v_lshlrev_b32 v240, 16, v180
  v_and_b32 v242, s34, v180
  v_lshlrev_b32 v245, 16, v197
  v_and_b32 v247, s34, v197
  v_lshlrev_b32 v241, 16, v181
  v_and_b32_e64 v243, s34, v181
  v_pk_mul_f32 v[196:197], v[132:133], v[246:247]
  v_pk_fma_f32 v[180:181], v[116:117], v[246:247], v[242:243] neg_lo:[1,0,0] neg_hi:[1,0,0]
  v_pk_mul_f32 v[132:133], v[132:133], v[244:245]
  v_pk_fma_f32 v[116:117], v[116:117], v[244:245], v[240:241] neg_lo:[1,0,0] neg_hi:[1,0,0]
  v_lshlrev_b32 v252, 16, v198
  v_and_b32 v254, s34, v198
  v_lshlrev_b32 v248, 16, v182
  v_and_b32 v250, s34, v182
  v_lshlrev_b32 v253, 16, v199
  v_and_b32 v255, s34, v199
  v_lshlrev_b32 v249, 16, v183
  v_and_b32 v251, s34, v183
  v_pk_mul_f32 v[198:199], v[134:135], v[254:255]
  v_pk_fma_f32 v[182:183], v[118:119], v[254:255], v[250:251] neg_lo:[1,0,0] neg_hi:[1,0,0]
  v_pk_mul_f32 v[134:135], v[134:135], v[252:253]
  v_pk_fma_f32 v[118:119], v[118:119], v[252:253], v[248:249] neg_lo:[1,0,0] neg_hi:[1,0,0]
  s_waitcnt vmcnt(10)
  v_lshlrev_b32 v244, 16, v200
  v_and_b32 v246, s34, v200
  v_lshlrev_b32 v240, 16, v184
  v_and_b32 v242, s34, v184
  v_lshlrev_b32 v245, 16, v201
  v_and_b32 v247, s34, v201
  v_lshlrev_b32 v241, 16, v185
  v_and_b32_e64 v243, s34, v185
  v_pk_mul_f32 v[200:201], v[136:137], v[246:247]
  v_pk_fma_f32 v[184:185], v[120:121], v[246:247], v[242:243] neg_lo:[1,0,0] neg_hi:[1,0,0]
  v_pk_mul_f32 v[136:137], v[136:137], v[244:245]
  v_pk_fma_f32 v[120:121], v[120:121], v[244:245], v[240:241] neg_lo:[1,0,0] neg_hi:[1,0,0]
  v_lshlrev_b32 v252, 16, v202
  v_and_b32 v254, s34, v202
  v_lshlrev_b32 v248, 16, v186
  v_and_b32 v250, s34, v186
  v_lshlrev_b32 v253, 16, v203
  v_and_b32 v255, s34, v203
  v_lshlrev_b32 v249, 16, v187
  v_and_b32 v251, s34, v187
  v_pk_mul_f32 v[202:203], v[138:139], v[254:255]
  v_pk_fma_f32 v[186:187], v[122:123], v[254:255], v[250:251] neg_lo:[1,0,0] neg_hi:[1,0,0]
  v_pk_mul_f32 v[138:139], v[138:139], v[252:253]
  v_pk_fma_f32 v[122:123], v[122:123], v[252:253], v[248:249] neg_lo:[1,0,0] neg_hi:[1,0,0]
  s_waitcnt vmcnt(8)
  v_lshlrev_b32 v244, 16, v204
  v_and_b32 v246, s34, v204
  v_lshlrev_b32 v240, 16, v188
  v_and_b32 v242, s34, v188
  v_lshlrev_b32 v245, 16, v205
  v_and_b32 v247, s34, v205
  v_lshlrev_b32 v241, 16, v189
  v_and_b32_e64 v243, s34, v189
  v_pk_mul_f32 v[204:205], v[140:141], v[246:247]
  v_pk_fma_f32 v[188:189], v[124:125], v[246:247], v[242:243] neg_lo:[1,0,0] neg_hi:[1,0,0]
  v_pk_mul_f32 v[140:141], v[140:141], v[244:245]
  v_pk_fma_f32 v[124:125], v[124:125], v[244:245], v[240:241] neg_lo:[1,0,0] neg_hi:[1,0,0]
  v_lshlrev_b32 v252, 16, v206
  v_and_b32 v254, s34, v206
  v_lshlrev_b32 v248, 16, v190
  v_and_b32 v250, s34, v190
  v_lshlrev_b32 v253, 16, v207
  v_and_b32 v255, s34, v207
  v_lshlrev_b32 v249, 16, v191
  v_and_b32 v251, s34, v191
  v_pk_mul_f32 v[206:207], v[142:143], v[254:255]
  v_pk_fma_f32 v[190:191], v[126:127], v[254:255], v[250:251] neg_lo:[1,0,0] neg_hi:[1,0,0]
  v_pk_mul_f32 v[142:143], v[142:143], v[252:253]
  v_pk_fma_f32 v[126:127], v[126:127], v[252:253], v[248:249] neg_lo:[1,0,0] neg_hi:[1,0,0]
  s_waitcnt vmcnt(0)
  s_barrier
  ds_read_b128 v[144:147], v11 offset:0
  ds_read_b128 v[148:151], v11 offset:4096
  ds_read_b128 v[152:155], v11 offset:8192
  ds_read_b128 v[156:159], v11 offset:12288
  ds_read_b128 v[160:163], v12 offset:0
  ds_read_b128 v[164:167], v12 offset:4096
  ds_read_b128 v[168:171], v12 offset:8192
  ds_read_b128 v[172:175], v12 offset:12288
  s_brev_b32 s35, 1
  s_cmp_eq_u32 s27, 1
  s_cselect_b32 s44, s35, 0
  s_waitcnt lgkmcnt(4)
  s_cbranch_scc1 K2_PRIM
  v_xor_b32 v144, s35, v144
  v_xor_b32 v145, s35, v145
  v_xor_b32 v146, s35, v146
  v_xor_b32 v147, s35, v147
  v_xor_b32 v148, s35, v148
  v_xor_b32 v149, s35, v149
  v_xor_b32 v150, s35, v150
  v_xor_b32 v151, s35, v151
  v_xor_b32 v152, s35, v152
  v_xor_b32 v153, s35, v153
  v_xor_b32 v154, s35, v154
  v_xor_b32 v155, s35, v155
  v_xor_b32 v156, s35, v156
  v_xor_b32 v157, s35, v157
  v_xor_b32 v158, s35, v158
  v_xor_b32 v159, s35, v159
  s_nop 1
K2_PRIM:
  v_mfma_f32_32x32x16_bf16 v[16:31], v[144:147], v[48:51], 0
  v_mfma_f32_32x32x16_bf16 v[32:47], v[144:147], v[64:67], 0
  s_waitcnt lgkmcnt(0)
  s_cmp_eq_u32 s17, 0
  s_cbranch_scc1 K2_NOSPEC2
  v_mov_b32 v160, v208
  v_mov_b32 v161, v209
  v_mov_b32 v162, v210
  v_mov_b32 v163, v211
  v_mov_b32 v164, v212
  v_mov_b32 v165, v213
  v_mov_b32 v166, v214
  v_mov_b32 v167, v215
  v_mov_b32 v168, v216
  v_mov_b32 v169, v217
  v_mov_b32 v170, v218
  v_mov_b32 v171, v219
  v_mov_b32 v172, v220
  v_mov_b32 v173, v221
  v_mov_b32 v174, v222
  v_mov_b32 v175, v223
K2_NOSPEC2:
  v_mfma_f32_32x32x16_bf16 v[16:31], v[148:151], v[52:55], v[16:31]
  v_xor_b32 v160, s44, v160
  v_xor_b32 v161, s44, v161
  v_xor_b32 v162, s44, v162
  v_mfma_f32_32x32x16_bf16 v[32:47], v[148:151], v[68:71], v[32:47]
  v_xor_b32 v163, s44, v163
  v_xor_b32 v164, s44, v164
  v_xor_b32 v165, s44, v165
  v_mfma_f32_32x32x16_bf16 v[16:31], v[152:155], v[56:59], v[16:31]
  v_xor_b32 v166, s44, v166
  v_xor_b32 v167, s44, v167
  v_xor_b32 v168, s44, v168
  v_mfma_f32_32x32x16_bf16 v[32:47], v[152:155], v[72:75], v[32:47]
  v_xor_b32 v169, s44, v169
  v_xor_b32 v170, s44, v170
  v_xor_b32 v171, s44, v171
  v_mfma_f32_32x32x16_bf16 v[16:31], v[156:159], v[60:63], v[16:31]
  v_xor_b32 v172, s44, v172
  v_xor_b32 v173, s44, v173
  v_xor_b32 v174, s44, v174
  v_mfma_f32_32x32x16_bf16 v[32:47], v[156:159], v[76:79], v[32:47]
  v_xor_b32_e64 v175, s44, v175
  v_mfma_f32_32x32x16_bf16 v[208:223], v[160:163], v[48:51], 0
  v_mfma_f32_32x32x16_bf16 v[224:239], v[160:163], v[64:67], 0
  v_mfma_f32_32x32x16_bf16 v[208:223], v[164:167], v[52:55], v[208:223]
  s_nop 3
  v_mul_f32 v4, v16, v80
  s_nop 2
  v_fmac_f32 v4, v32, v96
  v_mul_f32 v32, v32, v80
  v_fma_f32 v32, -v16, v96, v32
  v_cvt_pk_bf16_f32 v144, v4, v32
  v_mul_f32 v5, v17, v81
  v_fmac_f32 v5, v33, v97
  v_mfma_f32_32x32x16_bf16 v[224:239], v[164:167], v[68:71], v[224:239]
  v_mul_f32 v33, v33, v81
  v_fma_f32 v33, -v17, v97, v33
  v_cvt_pk_bf16_f32 v145, v5, v33
  v_mul_f32 v6, v18, v82
  v_fmac_f32 v6, v34, v98
  v_mul_f32_e64 v34, v34, v82
  v_fma_f32 v34, -v18, v98, v34
  v_mfma_f32_32x32x16_bf16 v[208:223], v[168:171], v[56:59], v[208:223]
  v_cvt_pk_bf16_f32 v146, v6, v34
  v_mul_f32 v7, v19, v83
  v_fmac_f32 v7, v35, v99
  v_mul_f32 v35, v35, v83
  v_fma_f32 v35, -v19, v99, v35
  v_cvt_pk_bf16_f32 v147, v7, v35
  v_mul_f32 v4, v20, v84
  v_mfma_f32_32x32x16_bf16 v[224:239], v[168:171], v[72:75], v[224:239]
  v_fmac_f32 v4, v36, v100
  v_mul_f32 v36, v36, v84
  v_fma_f32 v36, -v20, v100, v36
  v_cvt_pk_bf16_f32 v148, v4, v36
  v_mul_f32 v5, v21, v85
  v_fmac_f32 v5, v37, v101
  v_mul_f32_e64 v37, v37, v85
  v_mfma_f32_32x32x16_bf16 v[208:223], v[172:175], v[60:63], v[208:223]
  v_fma_f32 v37, -v21, v101, v37
  v_cvt_pk_bf16_f32 v149, v5, v37
  v_mul_f32 v6, v22, v86
  v_fmac_f32 v6, v38, v102
  v_mul_f32_e64 v38, v38, v86
  v_fma_f32 v38, -v22, v102, v38
  v_cvt_pk_bf16_f32 v150, v6, v38
  v_mfma_f32_32x32x16_bf16 v[224:239], v[172:175], v[76:79], v[224:239]
  v_mul_f32 v7, v23, v87
  v_fmac_f32 v7, v39, v103
  v_mul_f32_e64 v39, v39, v87
  v_fma_f32 v39, -v23, v103, v39
  v_cvt_pk_bf16_f32 v151, v7, v39
  v_pk_mul_f32 v[4:5], v[24:25], v[88:89]
  v_pk_fma_f32 v[4:5], v[40:41], v[104:105], v[4:5]
  v_pk_mul_f32 v[40:41], v[40:41], v[88:89]
  v_pk_fma_f32 v[40:41], v[24:25], v[104:105], v[40:41] neg_lo:[1,0,0] neg_hi:[1,0,0]
  v_cvt_pk_bf16_f32 v152, v4, v40
  v_cvt_pk_bf16_f32 v153, v5, v41
  v_pk_mul_f32 v[6:7], v[26:27], v[90:91]
  v_pk_fma_f32 v[6:7], v[42:43], v[106:107], v[6:7]
  v_pk_mul_f32 v[42:43], v[42:43], v[90:91]
  v_pk_fma_f32 v[42:43], v[26:27], v[106:107], v[42:43] neg_lo:[1,0,0] neg_hi:[1,0,0]
  v_cvt_pk_bf16_f32 v154, v6, v42
  v_cvt_pk_bf16_f32 v155, v7, v43
  v_pk_mul_f32 v[14:15], v[28:29], v[92:93]
  v_pk_fma_f32 v[14:15], v[44:45], v[108:109], v[14:15]
  v_pk_mul_f32 v[44:45], v[44:45], v[92:93]
  v_pk_fma_f32 v[44:45], v[28:29], v[108:109], v[44:45] neg_lo:[1,0,0] neg_hi:[1,0,0]
  v_cvt_pk_bf16_f32 v156, v14, v44
  v_cvt_pk_bf16_f32 v157, v15, v45
  v_pk_mul_f32 v[4:5], v[30:31], v[94:95]
  v_pk_fma_f32 v[4:5], v[46:47], v[110:111], v[4:5]
  v_pk_mul_f32 v[46:47], v[46:47], v[94:95]
  v_pk_fma_f32 v[46:47], v[30:31], v[110:111], v[46:47] neg_lo:[1,0,0] neg_hi:[1,0,0]
  v_cvt_pk_bf16_f32 v158, v4, v46
  v_cvt_pk_bf16_f32 v159, v5, v47
  v_mfma_f32_32x32x16_bf16 v[16:31], v[48:51], v[144:147], 0
  v_mul_f32 v4, v208, v80
  v_fmac_f32 v4, v224, v96
  v_mul_f32_e64 v224, v224, v80
  v_fma_f32 v224, -v208, v96, v224
  v_cvt_pk_bf16_f32 v160, v4, v224
  v_mfma_f32_32x32x16_bf16 v[32:47], v[64:67], v[144:147], 0
  v_mul_f32 v5, v209, v81
  v_fmac_f32 v5, v225, v97
  v_mul_f32_e64 v225, v225, v81
  v_fma_f32 v225, -v209, v97, v225
  v_cvt_pk_bf16_f32 v161, v5, v225
  v_mfma_f32_32x32x16_bf16 v[16:31], v[52:55], v[148:151], v[16:31]
  v_mul_f32 v6, v210, v82
  v_fmac_f32 v6, v226, v98
  v_mul_f32_e64 v226, v226, v82
  v_fma_f32 v226, -v210, v98, v226
  v_cvt_pk_bf16_f32 v162, v6, v226
  v_mfma_f32_32x32x16_bf16 v[32:47], v[68:71], v[148:151], v[32:47]
  v_mul_f32 v7, v211, v83
  v_fmac_f32 v7, v227, v99
  v_mul_f32_e64 v227, v227, v83
  v_fma_f32 v227, -v211, v99, v227
  v_cvt_pk_bf16_f32 v163, v7, v227
  v_mfma_f32_32x32x16_bf16 v[16:31], v[56:59], v[152:155], v[16:31]
  v_mul_f32 v4, v212, v84
  v_fmac_f32 v4, v228, v100
  v_mul_f32_e64 v228, v228, v84
  v_fma_f32 v228, -v212, v100, v228
  v_cvt_pk_bf16_f32 v164, v4, v228
  v_mfma_f32_32x32x16_bf16 v[32:47], v[72:75], v[152:155], v[32:47]
  v_mul_f32 v5, v213, v85
  v_fmac_f32 v5, v229, v101
  v_mul_f32_e64 v229, v229, v85
  v_fma_f32 v229, -v213, v101, v229
  v_cvt_pk_bf16_f32 v165, v5, v229
  v_mfma_f32_32x32x16_bf16 v[16:31], v[60:63], v[156:159], v[16:31]
  v_mul_f32 v6, v214, v86
  v_fmac_f32 v6, v230, v102
  v_mul_f32_e64 v230, v230, v86
  v_fma_f32 v230, -v214, v102, v230
  v_cvt_pk_bf16_f32 v166, v6, v230
  v_mfma_f32_32x32x16_bf16 v[32:47], v[76:79], v[156:159], v[32:47]
  v_mul_f32 v7, v215, v87
  v_fmac_f32 v7, v231, v103
  v_mul_f32_e64 v231, v231, v87
  v_fma_f32 v231, -v215, v103, v231
  v_cvt_pk_bf16_f32 v167, v7, v231
  v_pk_mul_f32 v[4:5], v[216:217], v[88:89]
  v_pk_fma_f32 v[4:5], v[232:233], v[104:105], v[4:5]
  v_pk_mul_f32 v[232:233], v[232:233], v[88:89]
  v_pk_fma_f32 v[232:233], v[216:217], v[104:105], v[232:233] neg_lo:[1,0,0] neg_hi:[1,0,0]
  v_cvt_pk_bf16_f32 v168, v4, v232
  v_cvt_pk_bf16_f32 v169, v5, v233
  v_pk_mul_f32 v[6:7], v[218:219], v[90:91]
  v_pk_fma_f32 v[6:7], v[234:235], v[106:107], v[6:7]
  v_pk_mul_f32 v[234:235], v[234:235], v[90:91]
  v_pk_fma_f32 v[234:235], v[218:219], v[106:107], v[234:235] neg_lo:[1,0,0] neg_hi:[1,0,0]
  v_cvt_pk_bf16_f32 v170, v6, v234
  v_cvt_pk_bf16_f32 v171, v7, v235
  v_pk_mul_f32 v[14:15], v[220:221], v[92:93]
  v_pk_fma_f32 v[14:15], v[236:237], v[108:109], v[14:15]
  v_pk_mul_f32 v[236:237], v[236:237], v[92:93]
  v_pk_fma_f32 v[236:237], v[220:221], v[108:109], v[236:237] neg_lo:[1,0,0] neg_hi:[1,0,0]
  v_cvt_pk_bf16_f32 v172, v14, v236
  v_cvt_pk_bf16_f32 v173, v15, v237
  v_pk_mul_f32 v[4:5], v[222:223], v[94:95]
  v_pk_fma_f32 v[4:5], v[238:239], v[110:111], v[4:5]
  v_pk_mul_f32 v[238:239], v[238:239], v[94:95]
  v_pk_fma_f32 v[238:239], v[222:223], v[110:111], v[238:239] neg_lo:[1,0,0] neg_hi:[1,0,0]
  v_cvt_pk_bf16_f32 v174, v4, v238
  v_cvt_pk_bf16_f32 v175, v5, v239
  v_mfma_f32_32x32x16_bf16 v[208:223], v[48:51], v[160:163], 0
  v_mfma_f32_32x32x16_bf16 v[224:239], v[64:67], v[160:163], 0
  v_mfma_f32_32x32x16_bf16 v[208:223], v[52:55], v[164:167], v[208:223]
  v_mul_f32 v144, v112, v16
  v_mul_f32 v160, v112, v32
  v_fma_f32 v144, -v176, v32, v144
  v_fmac_f32 v160, v176, v16
  v_mul_f32 v145, v113, v17
  v_mul_f32 v161, v113, v33
  v_fma_f32 v145, -v177, v33, v145
  v_fmac_f32 v161, v177, v17
  v_mfma_f32_32x32x16_bf16 v[224:239], v[68:71], v[164:167], v[224:239]
  v_mul_f32 v146, v114, v18
  v_mul_f32 v162, v114, v34
  v_fma_f32 v146, -v178, v34, v146
  v_fmac_f32 v162, v178, v18
  v_mul_f32 v147, v115, v19
  v_mul_f32 v163, v115, v35
  v_fma_f32 v147, -v179, v35, v147
  v_fmac_f32 v163, v179, v19
  v_mfma_f32_32x32x16_bf16 v[208:223], v[56:59], v[168:171], v[208:223]
  v_mul_f32 v148, v116, v20
  v_mul_f32 v164, v116, v36
  v_fma_f32 v148, -v180, v36, v148
  v_fmac_f32 v164, v180, v20
  v_mul_f32 v149, v117, v21
  v_mul_f32 v165, v117, v37
  v_fma_f32 v149, -v181, v37, v149
  v_fmac_f32 v165, v181, v21
  v_mfma_f32_32x32x16_bf16 v[224:239], v[72:75], v[168:171], v[224:239]
  v_mul_f32 v150, v118, v22
  v_mul_f32 v166, v118, v38
  v_fma_f32 v150, -v182, v38, v150
  v_fmac_f32 v166, v182, v22
  v_mul_f32 v151, v119, v23
  v_mul_f32 v167, v119, v39
  v_fma_f32 v151, -v183, v39, v151
  v_fmac_f32 v167, v183, v23
  v_mfma_f32_32x32x16_bf16 v[208:223], v[60:63], v[172:175], v[208:223]
  v_mul_f32 v152, v120, v24
  v_mul_f32 v168, v120, v40
  v_fma_f32 v152, -v184, v40, v152
  v_fmac_f32 v168, v184, v24
  v_mul_f32 v153, v121, v25
  v_mul_f32 v169, v121, v41
  v_fma_f32 v153, -v185, v41, v153
  v_fmac_f32 v169, v185, v25
  v_mfma_f32_32x32x16_bf16 v[224:239], v[76:79], v[172:175], v[224:239]
  v_mul_f32 v154, v122, v26
  v_mul_f32 v170, v122, v42
  v_fma_f32 v154, -v186, v42, v154
  v_fmac_f32 v170, v186, v26
  v_mul_f32 v155, v123, v27
  v_mul_f32 v171, v123, v43
  v_fma_f32 v155, -v187, v43, v155
  v_fmac_f32 v171, v187, v27
  v_pk_mul_f32 v[156:157], v[124:125], v[28:29]
  v_pk_mul_f32 v[172:173], v[124:125], v[44:45]
  v_pk_fma_f32 v[156:157], v[188:189], v[44:45], v[156:157] neg_lo:[1,0,0] neg_hi:[1,0,0]
  v_pk_fma_f32 v[172:173], v[188:189], v[28:29], v[172:173]
  v_pk_mul_f32 v[158:159], v[126:127], v[30:31]
  v_pk_mul_f32 v[174:175], v[126:127], v[46:47]
  v_pk_fma_f32 v[158:159], v[190:191], v[46:47], v[158:159] neg_lo:[1,0,0] neg_hi:[1,0,0]
  v_pk_fma_f32 v[174:175], v[190:191], v[30:31], v[174:175]
  v_pk_fma_f32 v[144:145], v[128:129], v[224:225], v[144:145] neg_lo:[1,0,0] neg_hi:[1,0,0]
  v_pk_fma_f32 v[160:161], v[128:129], v[208:209], v[160:161]
  v_pk_fma_f32 v[144:145], v[192:193], v[208:209], v[144:145] neg_lo:[1,0,0] neg_hi:[1,0,0]
  v_pk_fma_f32 v[160:161], v[192:193], v[224:225], v[160:161] neg_lo:[1,0,0] neg_hi:[1,0,0]
  v_pk_fma_f32 v[146:147], v[130:131], v[226:227], v[146:147] neg_lo:[1,0,0] neg_hi:[1,0,0]
  v_pk_fma_f32 v[162:163], v[130:131], v[210:211], v[162:163]
  v_pk_fma_f32 v[146:147], v[194:195], v[210:211], v[146:147] neg_lo:[1,0,0] neg_hi:[1,0,0]
  v_pk_fma_f32 v[162:163], v[194:195], v[226:227], v[162:163] neg_lo:[1,0,0] neg_hi:[1,0,0]
  v_pk_fma_f32 v[148:149], v[132:133], v[228:229], v[148:149] neg_lo:[1,0,0] neg_hi:[1,0,0]
  v_pk_fma_f32 v[164:165], v[132:133], v[212:213], v[164:165]
  v_pk_fma_f32 v[148:149], v[196:197], v[212:213], v[148:149] neg_lo:[1,0,0] neg_hi:[1,0,0]
  v_pk_fma_f32 v[164:165], v[196:197], v[228:229], v[164:165] neg_lo:[1,0,0] neg_hi:[1,0,0]
  v_pk_fma_f32 v[150:151], v[134:135], v[230:231], v[150:151] neg_lo:[1,0,0] neg_hi:[1,0,0]
  v_pk_fma_f32 v[166:167], v[134:135], v[214:215], v[166:167]
  v_pk_fma_f32 v[150:151], v[198:199], v[214:215], v[150:151] neg_lo:[1,0,0] neg_hi:[1,0,0]
  v_pk_fma_f32 v[166:167], v[198:199], v[230:231], v[166:167] neg_lo:[1,0,0] neg_hi:[1,0,0]
  v_pk_fma_f32 v[152:153], v[136:137], v[232:233], v[152:153] neg_lo:[1,0,0] neg_hi:[1,0,0]
  v_pk_fma_f32 v[168:169], v[136:137], v[216:217], v[168:169]
  v_pk_fma_f32 v[152:153], v[200:201], v[216:217], v[152:153] neg_lo:[1,0,0] neg_hi:[1,0,0]
  v_pk_fma_f32 v[168:169], v[200:201], v[232:233], v[168:169] neg_lo:[1,0,0] neg_hi:[1,0,0]
  v_pk_fma_f32 v[154:155], v[138:139], v[234:235], v[154:155] neg_lo:[1,0,0] neg_hi:[1,0,0]
  v_pk_fma_f32 v[170:171], v[138:139], v[218:219], v[170:171]
  v_pk_fma_f32 v[154:155], v[202:203], v[218:219], v[154:155] neg_lo:[1,0,0] neg_hi:[1,0,0]
  v_pk_fma_f32 v[170:171], v[202:203], v[234:235], v[170:171] neg_lo:[1,0,0] neg_hi:[1,0,0]
  v_pk_fma_f32 v[156:157], v[140:141], v[236:237], v[156:157] neg_lo:[1,0,0] neg_hi:[1,0,0]
  v_pk_fma_f32 v[172:173], v[140:141], v[220:221], v[172:173]
  v_pk_fma_f32 v[156:157], v[204:205], v[220:221], v[156:157] neg_lo:[1,0,0] neg_hi:[1,0,0]
  v_pk_fma_f32 v[172:173], v[204:205], v[236:237], v[172:173] neg_lo:[1,0,0] neg_hi:[1,0,0]
  v_pk_fma_f32 v[158:159], v[142:143], v[238:239], v[158:159] neg_lo:[1,0,0] neg_hi:[1,0,0]
  v_pk_fma_f32 v[174:175], v[142:143], v[222:223], v[174:175]
  v_pk_fma_f32 v[158:159], v[206:207], v[222:223], v[158:159] neg_lo:[1,0,0] neg_hi:[1,0,0]
  v_pk_fma_f32 v[174:175], v[206:207], v[238:239], v[174:175] neg_lo:[1,0,0] neg_hi:[1,0,0]
  s_lshr_b32 s48, s2, 5
  s_lshl_b32 s48, s48, 7
  s_and_b32 s49, s2, 31
  s_add_u32 s48, s48, s49
  s_lshl_b32 s49, s3, 5
  s_add_u32 s48, s48, s49
  s_mov_b32 s56, s4
  s_mov_b32 s57, s5
  s_mov_b32 s58, 0x400000
  s_mov_b32 s59, 0x20000
  s_lshl_b32 s49, s48, 12
  s_add_u32 s60, s8, 0xe80000
  s_addc_u32 s61, s9, 0
  s_lshl_b32 s62, s48, 4
  s_load_dwordx4 s[64:67], s[60:61], s62
  v_cvt_pk_bf16_f32 v176, v144, -v160
  v_cvt_pk_bf16_f32 v177, v145, -v161
  v_cvt_pk_bf16_f32 v178, v146, -v162
  v_cvt_pk_bf16_f32 v179, v147, -v163
  s_nop 1
  v_mfma_f32_32x32x16_bf16 v[16:31], v[176:179], v[48:51], 0
  v_cvt_pk_bf16_f32 v180, v148, -v164
  v_cvt_pk_bf16_f32 v181, v149, -v165
  v_mfma_f32_32x32x16_bf16 v[32:47], v[176:179], v[64:67], 0
  v_cvt_pk_bf16_f32 v182, v150, -v166
  v_cvt_pk_bf16_f32 v183, v151, -v167
  s_nop 1
  v_mfma_f32_32x32x16_bf16 v[16:31], v[180:183], v[52:55], v[16:31]
  v_cvt_pk_bf16_f32 v184, v152, -v168
  v_cvt_pk_bf16_f32 v185, v153, -v169
  v_mfma_f32_32x32x16_bf16 v[32:47], v[180:183], v[68:71], v[32:47]
  v_cvt_pk_bf16_f32 v186, v154, -v170
  v_cvt_pk_bf16_f32 v187, v155, -v171
  s_nop 1
  v_mfma_f32_32x32x16_bf16 v[16:31], v[184:187], v[56:59], v[16:31]
  v_cvt_pk_bf16_f32 v188, v156, -v172
  v_cvt_pk_bf16_f32 v189, v157, -v173
  v_mfma_f32_32x32x16_bf16 v[32:47], v[184:187], v[72:75], v[32:47]
  v_cvt_pk_bf16_f32 v190, v158, -v174
  v_cvt_pk_bf16_f32 v191, v159, -v175
  s_nop 1
  v_mfma_f32_32x32x16_bf16 v[16:31], v[188:191], v[60:63], v[16:31]
  v_mfma_f32_32x32x16_bf16 v[32:47], v[188:191], v[76:79], v[32:47]
  s_nop 10
  v_pk_mul_f32 v[4:5], v[16:17], v[80:81]
  v_pk_fma_f32 v[4:5], v[32:33], v[96:97], v[4:5]
  v_pk_mul_f32 v[32:33], v[32:33], v[80:81]
  v_pk_fma_f32 v[32:33], v[16:17], v[96:97], v[32:33] neg_lo:[1,0,0] neg_hi:[1,0,0]
  v_cvt_pk_bf16_f32 v192, v4, v32
  v_cvt_pk_bf16_f32 v193, v5, v33
  v_pk_mul_f32 v[6:7], v[18:19], v[82:83]
  v_pk_fma_f32 v[6:7], v[34:35], v[98:99], v[6:7]
  v_pk_mul_f32 v[34:35], v[34:35], v[82:83]
  v_pk_fma_f32 v[34:35], v[18:19], v[98:99], v[34:35] neg_lo:[1,0,0] neg_hi:[1,0,0]
  v_cvt_pk_bf16_f32 v194, v6, v34
  v_cvt_pk_bf16_f32 v195, v7, v35
  v_pk_mul_f32 v[14:15], v[20:21], v[84:85]
  v_pk_fma_f32 v[14:15], v[36:37], v[100:101], v[14:15]
  v_pk_mul_f32 v[36:37], v[36:37], v[84:85]
  v_pk_fma_f32 v[36:37], v[20:21], v[100:101], v[36:37] neg_lo:[1,0,0] neg_hi:[1,0,0]
  v_cvt_pk_bf16_f32 v196, v14, v36
  v_cvt_pk_bf16_f32 v197, v15, v37
  v_pk_mul_f32 v[4:5], v[22:23], v[86:87]
  v_pk_fma_f32 v[4:5], v[38:39], v[102:103], v[4:5]
  v_pk_mul_f32 v[38:39], v[38:39], v[86:87]
  v_pk_fma_f32 v[38:39], v[22:23], v[102:103], v[38:39] neg_lo:[1,0,0] neg_hi:[1,0,0]
  v_cvt_pk_bf16_f32 v198, v4, v38
  v_cvt_pk_bf16_f32 v199, v5, v39
  v_pk_mul_f32 v[6:7], v[24:25], v[88:89]
  v_pk_fma_f32 v[6:7], v[40:41], v[104:105], v[6:7]
  v_pk_mul_f32 v[40:41], v[40:41], v[88:89]
  v_pk_fma_f32 v[40:41], v[24:25], v[104:105], v[40:41] neg_lo:[1,0,0] neg_hi:[1,0,0]
  v_cvt_pk_bf16_f32 v200, v6, v40
  v_cvt_pk_bf16_f32 v201, v7, v41
  v_pk_mul_f32 v[14:15], v[26:27], v[90:91]
  v_pk_fma_f32 v[14:15], v[42:43], v[106:107], v[14:15]
  v_pk_mul_f32 v[42:43], v[42:43], v[90:91]
  v_pk_fma_f32 v[42:43], v[26:27], v[106:107], v[42:43] neg_lo:[1,0,0] neg_hi:[1,0,0]
  v_cvt_pk_bf16_f32 v202, v14, v42
  v_cvt_pk_bf16_f32 v203, v15, v43
  v_pk_mul_f32 v[4:5], v[28:29], v[92:93]
  v_pk_fma_f32 v[4:5], v[44:45], v[108:109], v[4:5]
  v_pk_mul_f32 v[44:45], v[44:45], v[92:93]
  v_pk_fma_f32 v[44:45], v[28:29], v[108:109], v[44:45] neg_lo:[1,0,0] neg_hi:[1,0,0]
  v_cvt_pk_bf16_f32 v204, v4, v44
  v_cvt_pk_bf16_f32 v205, v5, v45
  v_pk_mul_f32 v[6:7], v[30:31], v[94:95]
  v_pk_fma_f32 v[6:7], v[46:47], v[110:111], v[6:7]
  v_pk_mul_f32 v[46:47], v[46:47], v[94:95]
  v_pk_fma_f32 v[46:47], v[30:31], v[110:111], v[46:47] neg_lo:[1,0,0] neg_hi:[1,0,0]
  v_cvt_pk_bf16_f32 v206, v6, v46
  v_cvt_pk_bf16_f32 v207, v7, v47
  ds_write_b128 v8, v[192:195] offset:0
  ds_write_b128 v8, v[196:199] offset:32
  ds_write_b128 v8, v[200:203] offset:64
  ds_write_b128 v8, v[204:207] offset:96
  s_waitcnt lgkmcnt(0)
  s_barrier
  ds_read_b128 v[144:147], v9 offset:0
  ds_read_b128 v[148:151], v9 offset:32
  ds_read_b128 v[152:155], v9 offset:64
  ds_read_b128 v[156:159], v9 offset:96
  s_waitcnt lgkmcnt(3)
  v_mfma_f32_32x32x16_bf16 v[16:31], v[144:147], v[48:51], 0
  v_mfma_f32_32x32x16_bf16 v[32:47], v[144:147], v[64:67], 0
  s_waitcnt lgkmcnt(2)
  v_mfma_f32_32x32x16_bf16 v[16:31], v[148:151], v[52:55], v[16:31]
  v_mfma_f32_32x32x16_bf16 v[32:47], v[148:151], v[68:71], v[32:47]
  s_waitcnt lgkmcnt(1)
  v_mfma_f32_32x32x16_bf16 v[16:31], v[152:155], v[56:59], v[16:31]
  v_mfma_f32_32x32x16_bf16 v[32:47], v[152:155], v[72:75], v[32:47]
  s_waitcnt lgkmcnt(0)
  v_mfma_f32_32x32x16_bf16 v[16:31], v[156:159], v[60:63], v[16:31]
  v_mfma_f32_32x32x16_bf16 v[32:47], v[156:159], v[76:79], v[32:47]
  s_mul_i32 s40, s3, 262144
  s_lshl_b32 s41, s10, 7
  s_add_u32 s40, s40, s41
  s_add_u32 s41, s40, 65536
  s_add_u32 s42, s40, 131072
  s_add_u32 s43, s40, 196608
  s_nop 11
  s_cmp_eq_u32 s27, 1
  s_cbranch_scc1 K2_OUTP
  v_cvt_pk_bf16_f32 v176, v16, -v32
  v_cvt_pk_bf16_f32 v177, v17, -v33
  v_cvt_pk_bf16_f32 v178, v18, -v34
  v_cvt_pk_bf16_f32 v179, v19, -v35
  buffer_store_dwordx4 v[176:179], v10, s[36:39], s40 offen sc0 sc1
  v_cvt_pk_bf16_f32 v180, v20, -v36
  v_cvt_pk_bf16_f32 v181, v21, -v37
  v_cvt_pk_bf16_f32 v182, v22, -v38
  v_cvt_pk_bf16_f32 v183, v23, -v39
  buffer_store_dwordx4 v[180:183], v10, s[36:39], s41 offen sc0 sc1
  v_cvt_pk_bf16_f32 v184, v24, -v40
  v_cvt_pk_bf16_f32 v185, v25, -v41
  v_cvt_pk_bf16_f32 v186, v26, -v42
  v_cvt_pk_bf16_f32 v187, v27, -v43
  buffer_store_dwordx4 v[184:187], v10, s[36:39], s42 offen sc0 sc1
  v_cvt_pk_bf16_f32 v188, v28, -v44
  v_cvt_pk_bf16_f32 v189, v29, -v45
  v_cvt_pk_bf16_f32 v190, v30, -v46
  v_cvt_pk_bf16_f32 v191, v31, -v47
  buffer_store_dwordx4 v[188:191], v10, s[36:39], s43 offen sc0 sc1
  s_branch K2_OUTDONE
K2_OUTP:
  v_cvt_pk_bf16_f32 v176, v16, v32
  v_cvt_pk_bf16_f32 v177, v17, v33
  v_cvt_pk_bf16_f32 v178, v18, v34
  v_cvt_pk_bf16_f32 v179, v19, v35
  buffer_store_dwordx4 v[176:179], v10, s[36:39], s40 offen sc0 sc1
  v_cvt_pk_bf16_f32 v180, v20, v36
  v_cvt_pk_bf16_f32 v181, v21, v37
  v_cvt_pk_bf16_f32 v182, v22, v38
  v_cvt_pk_bf16_f32 v183, v23, v39
  buffer_store_dwordx4 v[180:183], v10, s[36:39], s41 offen sc0 sc1
  v_cvt_pk_bf16_f32 v184, v24, v40
  v_cvt_pk_bf16_f32 v185, v25, v41
  v_cvt_pk_bf16_f32 v186, v26, v42
  v_cvt_pk_bf16_f32 v187, v27, v43
  buffer_store_dwordx4 v[184:187], v10, s[36:39], s42 offen sc0 sc1
  v_cvt_pk_bf16_f32 v188, v28, v44
  v_cvt_pk_bf16_f32 v189, v29, v45
  v_cvt_pk_bf16_f32 v190, v30, v46
  v_cvt_pk_bf16_f32 v191, v31, v47
  buffer_store_dwordx4 v[188:191], v10, s[36:39], s43 offen sc0 sc1
K2_OUTDONE:
  s_mov_b32 s11, s48
  s_lshl_b32 s24, s11, 12
  s_mov_b32 s28, s64
  s_mov_b32 s29, s65
  s_mov_b32 s30, s66
  s_mov_b32 s31, s67
  s_add_u32 s32, s8, 0xdfc000
  s_addc_u32 s33, s9, 0
  s_mov_b32 s34, 0x8000
  s_mov_b32 s35, 0x20000
  s_waitcnt vmcnt(0)
  s_barrier
  s_cmp_eq_u32 s3, 0
  s_cbranch_scc0 F3_NOFLAG
  s_mul_i32 s40, s10, 128
  v_mov_b32 v4, 1
  v_mul_u32_u24 v5, 32768, v1
  s_mov_b64 exec, 1
  buffer_store_dword v4, v5, s[32:35], s40 offen sc0 sc1
  s_mov_b64 exec, -1
F3_NOFLAG:
  s_setprio 0
  buffer_load_dwordx4 v[208:211], v2, s[56:59], s49 offen offset:0
  buffer_load_dwordx4 v[212:215], v2, s[56:59], s49 offen offset:1024
  buffer_load_dwordx4 v[216:219], v2, s[56:59], s49 offen offset:2048
  buffer_load_dwordx4 v[220:223], v2, s[56:59], s49 offen offset:3072
  s_add_u32 s16, s8, 0xe80000
  s_addc_u32 s17, s9, 0
  s_mov_b32 s18, 0x8000
  s_mov_b32 s19, 0x20000
  v_lshlrev_b32 v4, 4, v0
  s_movk_i32 s25, 16384
  buffer_load_dwordx4 v[224:227], v4, s[16:19], s25 offen
  s_mov_b32 s36, s6
  s_mov_b32 s37, s7
  s_mov_b32 s38, 0x400000
  s_mov_b32 s39, 0x20000
  s_add_u32 s20, s8, 0x1800000
  s_addc_u32 s21, s9, 0
  s_mov_b32 s22, 0x400000
  s_mov_b32 s23, 0x20000
  v_bfe_u32 v4, v1, 2, 2
  v_lshlrev_b32 v5, 6, v1
  v_xor_b32 v6, s3, v4
  v_lshlrev_b32 v6, 4, v6
  v_add_u32 v8, v5, v6
  s_mul_i32 s43, s3, 5120
  s_add_u32 s43, s43, 16384
  v_and_b32 v4, 31, v1
  v_mul_u32_u24 v4, 80, v4
  v_lshrrev_b32 v6, 5, v1
  v_lshlrev_b32 v6, 3, v6
  v_add3_u32 v9, v4, v6, s43
  v_lshrrev_b32 v4, 2, v1
  v_mul_u32_u24 v4, 80, v4
  v_and_b32 v6, 3, v1
  v_lshlrev_b32 v6, 4, v6
  v_add3_u32 v10, v4, v6, s43
  v_mul_u32_u24 v11, 128, v1
  v_lshrrev_b32 v13, 2, v1
  v_lshlrev_b32 v13, 7, v13
  v_and_b32 v4, 3, v1
  v_lshl_add_u32 v13, v4, 4, v13
  v_mov_b32 v240, s28
  v_mov_b32 v242, s29
  v_mul_f32 v244, 0xbfb8aa3b, v240
  v_mul_f32 v246, 0xbfb8aa3b, v242
  v_mul_f32 v240, 0x35000000, v240
  v_mul_f32 v242, 0x35000000, v242
  v_mov_b32 v248, s30
  v_mov_b32 v250, s31
  v_mul_f32 v252, 0xbfb8aa3b, v248
  v_mul_f32 v254, 0xbfb8aa3b, v250
  v_mul_f32 v248, 0x35000000, v248
  v_mul_f32 v250, 0x35000000, v250
  s_mov_b32 s44, 0xffff0000
  s_waitcnt vmcnt(4)
  v_lshlrev_b32 v160, 16, v208
  v_lshlrev_b32 v162, 16, v209
  v_and_b32 v161, s44, v208
  v_and_b32_e64 v163, s44, v209
  v_pk_fma_f32 v[192:193], v[160:161], v[244:245], v[246:247] op_sel_hi:[1,0,0]
  v_pk_fma_f32 v[196:197], v[162:163], v[244:245], v[246:247] op_sel_hi:[1,0,0]
  v_pk_fma_f32 v[112:113], v[160:161], v[240:241], v[242:243] op_sel_hi:[1,0,0]
  v_pk_fma_f32 v[114:115], v[162:163], v[240:241], v[242:243] op_sel_hi:[1,0,0]
  v_exp_f32 v192, v192
  v_exp_f32 v196, v196
  v_exp_f32 v193, v193
  v_exp_f32 v197, v197
  v_pk_add_f32 v[192:193], v[192:193], 1.0 op_sel_hi:[1,0]
  v_pk_add_f32 v[196:197], v[196:197], 1.0 op_sel_hi:[1,0]
  v_rcp_f32 v192, v192
  v_rcp_f32 v196, v196
  v_rcp_f32 v193, v193
  v_rcp_f32 v197, v197
  v_pk_mul_f32 v[112:113], v[112:113], v[192:193]
  v_pk_mul_f32 v[114:115], v[114:115], v[196:197]
  v_lshlrev_b32 v164, 16, v210
  v_lshlrev_b32 v166, 16, v211
  v_and_b32 v165, s44, v210
  v_and_b32 v167, s44, v211
  v_pk_fma_f32 v[200:201], v[164:165], v[244:245], v[246:247] op_sel_hi:[1,0,0]
  v_pk_fma_f32 v[204:205], v[166:167], v[244:245], v[246:247] op_sel_hi:[1,0,0]
  v_pk_fma_f32 v[116:117], v[164:165], v[240:241], v[242:243] op_sel_hi:[1,0,0]
  v_pk_fma_f32 v[118:119], v[166:167], v[240:241], v[242:243] op_sel_hi:[1,0,0]
  v_exp_f32 v200, v200
  v_exp_f32 v204, v204
  v_exp_f32 v201, v201
  v_exp_f32 v205, v205
  v_pk_add_f32 v[200:201], v[200:201], 1.0 op_sel_hi:[1,0]
  v_pk_add_f32 v[204:205], v[204:205], 1.0 op_sel_hi:[1,0]
  v_rcp_f32 v200, v200
  v_rcp_f32 v204, v204
  v_rcp_f32 v201, v201
  v_rcp_f32 v205, v205
  v_pk_mul_f32 v[116:117], v[116:117], v[200:201]
  v_pk_mul_f32 v[118:119], v[118:119], v[204:205]
  s_waitcnt vmcnt(3)
  v_lshlrev_b32 v168, 16, v212
  v_lshlrev_b32 v170, 16, v213
  v_and_b32 v169, s44, v212
  v_and_b32_e64 v171, s44, v213
  v_pk_fma_f32 v[192:193], v[168:169], v[244:245], v[246:247] op_sel_hi:[1,0,0]
  v_pk_fma_f32 v[196:197], v[170:171], v[244:245], v[246:247] op_sel_hi:[1,0,0]
  v_pk_fma_f32 v[120:121], v[168:169], v[240:241], v[242:243] op_sel_hi:[1,0,0]
  v_pk_fma_f32 v[122:123], v[170:171], v[240:241], v[242:243] op_sel_hi:[1,0,0]
  v_exp_f32 v192, v192
  v_exp_f32 v196, v196
  v_exp_f32 v193, v193
  v_exp_f32 v197, v197
  v_pk_add_f32 v[192:193], v[192:193], 1.0 op_sel_hi:[1,0]
  v_pk_add_f32 v[196:197], v[196:197], 1.0 op_sel_hi:[1,0]
  v_rcp_f32 v192, v192
  v_rcp_f32 v196, v196
  v_rcp_f32 v193, v193
  v_rcp_f32 v197, v197
  v_pk_mul_f32 v[120:121], v[120:121], v[192:193]
  v_pk_mul_f32 v[122:123], v[122:123], v[196:197]
  v_lshlrev_b32 v172, 16, v214
  v_lshlrev_b32 v174, 16, v215
  v_and_b32 v173, s44, v214
  v_and_b32 v175, s44, v215
  v_pk_fma_f32 v[200:201], v[172:173], v[244:245], v[246:247] op_sel_hi:[1,0,0]
  v_pk_fma_f32 v[204:205], v[174:175], v[244:245], v[246:247] op_sel_hi:[1,0,0]
  v_pk_fma_f32 v[124:125], v[172:173], v[240:241], v[242:243] op_sel_hi:[1,0,0]
  v_pk_fma_f32 v[126:127], v[174:175], v[240:241], v[242:243] op_sel_hi:[1,0,0]
  v_exp_f32 v200, v200
  v_exp_f32 v204, v204
  v_exp_f32 v201, v201
  v_exp_f32 v205, v205
  v_pk_add_f32 v[200:201], v[200:201], 1.0 op_sel_hi:[1,0]
  v_pk_add_f32 v[204:205], v[204:205], 1.0 op_sel_hi:[1,0]
  v_rcp_f32 v200, v200
  v_rcp_f32 v204, v204
  v_rcp_f32 v201, v201
  v_rcp_f32 v205, v205
  v_pk_mul_f32 v[124:125], v[124:125], v[200:201]
  v_pk_mul_f32 v[126:127], v[126:127], v[204:205]
  s_waitcnt vmcnt(2)
  v_lshlrev_b32 v176, 16, v216
  v_lshlrev_b32 v178, 16, v217
  v_and_b32 v177, s44, v216
  v_and_b32_e64 v179, s44, v217
  v_pk_fma_f32 v[192:193], v[176:177], v[252:253], v[254:255] op_sel_hi:[1,0,0]
  v_pk_fma_f32 v[196:197], v[178:179], v[252:253], v[254:255] op_sel_hi:[1,0,0]
  v_pk_fma_f32 v[128:129], v[176:177], v[248:249], v[250:251] op_sel_hi:[1,0,0]
  v_pk_fma_f32 v[130:131], v[178:179], v[248:249], v[250:251] op_sel_hi:[1,0,0]
  v_exp_f32 v192, v192
  v_exp_f32 v196, v196
  v_exp_f32 v193, v193
  v_exp_f32 v197, v197
  v_pk_add_f32 v[192:193], v[192:193], 1.0 op_sel_hi:[1,0]
  v_pk_add_f32 v[196:197], v[196:197], 1.0 op_sel_hi:[1,0]
  v_rcp_f32 v192, v192
  v_rcp_f32 v196, v196
  v_rcp_f32 v193, v193
  v_rcp_f32 v197, v197
  v_pk_mul_f32 v[128:129], v[128:129], v[192:193]
  v_pk_mul_f32 v[130:131], v[130:131], v[196:197]
  v_lshlrev_b32 v180, 16, v218
  v_lshlrev_b32 v182, 16, v219
  v_and_b32 v181, s44, v218
  v_and_b32 v183, s44, v219
  v_pk_fma_f32 v[200:201], v[180:181], v[252:253], v[254:255] op_sel_hi:[1,0,0]
  v_pk_fma_f32 v[204:205], v[182:183], v[252:253], v[254:255] op_sel_hi:[1,0,0]
  v_pk_fma_f32 v[132:133], v[180:181], v[248:249], v[250:251] op_sel_hi:[1,0,0]
  v_pk_fma_f32 v[134:135], v[182:183], v[248:249], v[250:251] op_sel_hi:[1,0,0]
  v_exp_f32 v200, v200
  v_exp_f32 v204, v204
  v_exp_f32 v201, v201
  v_exp_f32 v205, v205
  v_pk_add_f32 v[200:201], v[200:201], 1.0 op_sel_hi:[1,0]
  v_pk_add_f32 v[204:205], v[204:205], 1.0 op_sel_hi:[1,0]
  v_rcp_f32 v200, v200
  v_rcp_f32 v204, v204
  v_rcp_f32 v201, v201
  v_rcp_f32 v205, v205
  v_pk_mul_f32 v[132:133], v[132:133], v[200:201]
  v_pk_mul_f32 v[134:135], v[134:135], v[204:205]
  s_waitcnt vmcnt(1)
  v_lshlrev_b32 v184, 16, v220
  v_lshlrev_b32 v186, 16, v221
  v_and_b32 v185, s44, v220
  v_and_b32_e64 v187, s44, v221
  v_pk_fma_f32 v[192:193], v[184:185], v[252:253], v[254:255] op_sel_hi:[1,0,0]
  v_pk_fma_f32 v[196:197], v[186:187], v[252:253], v[254:255] op_sel_hi:[1,0,0]
  v_pk_fma_f32 v[136:137], v[184:185], v[248:249], v[250:251] op_sel_hi:[1,0,0]
  v_pk_fma_f32 v[138:139], v[186:187], v[248:249], v[250:251] op_sel_hi:[1,0,0]
  v_exp_f32 v192, v192
  v_exp_f32 v196, v196
  v_exp_f32 v193, v193
  v_exp_f32 v197, v197
  v_pk_add_f32 v[192:193], v[192:193], 1.0 op_sel_hi:[1,0]
  v_pk_add_f32 v[196:197], v[196:197], 1.0 op_sel_hi:[1,0]
  v_rcp_f32 v192, v192
  v_rcp_f32 v196, v196
  v_rcp_f32 v193, v193
  v_rcp_f32 v197, v197
  v_pk_mul_f32 v[136:137], v[136:137], v[192:193]
  v_pk_mul_f32 v[138:139], v[138:139], v[196:197]
  v_lshlrev_b32 v188, 16, v222
  v_lshlrev_b32 v190, 16, v223
  v_and_b32 v189, s44, v222
  v_and_b32 v191, s44, v223
  v_pk_fma_f32 v[200:201], v[188:189], v[252:253], v[254:255] op_sel_hi:[1,0,0]
  v_pk_fma_f32 v[204:205], v[190:191], v[252:253], v[254:255] op_sel_hi:[1,0,0]
  v_pk_fma_f32 v[140:141], v[188:189], v[248:249], v[250:251] op_sel_hi:[1,0,0]
  v_pk_fma_f32 v[142:143], v[190:191], v[248:249], v[250:251] op_sel_hi:[1,0,0]
  v_exp_f32 v200, v200
  v_exp_f32 v204, v204
  v_exp_f32 v201, v201
  v_exp_f32 v205, v205
  v_pk_add_f32 v[200:201], v[200:201], 1.0 op_sel_hi:[1,0]
  v_pk_add_f32 v[204:205], v[204:205], 1.0 op_sel_hi:[1,0]
  v_rcp_f32 v200, v200
  v_rcp_f32 v204, v204
  v_rcp_f32 v201, v201
  v_rcp_f32 v205, v205
  v_pk_mul_f32 v[140:141], v[140:141], v[200:201]
  v_pk_mul_f32 v[142:143], v[142:143], v[204:205]
  s_waitcnt vmcnt(0)
  v_max_u32 v224, v224, v225
  v_max3_u32 v224, v224, v226, v227
  s_nop 1
  v_max_u32_dpp v224, v224, v224 quad_perm:[1,0,3,2] row_mask:0xf bank_mask:0xf
  s_nop 1
  v_max_u32_dpp v224, v224, v224 quad_perm:[2,3,0,1] row_mask:0xf bank_mask:0xf
  s_nop 1
  v_max_u32_dpp v224, v224, v224 row_half_mirror row_mask:0xf bank_mask:0xf
  s_nop 1
  v_max_u32_dpp v224, v224, v224 row_mirror row_mask:0xf bank_mask:0xf
  v_mov_b32 v228, v224
  s_nop 1
  v_permlane16_swap_b32 v228, v224
  v_max_u32 v224, v228, v224
  v_mov_b32 v228, v224
  s_nop 1
  v_permlane32_swap_b32 v228, v224
  v_max_u32 v224, v228, v224
  s_lshl_b32 s42, s3, 2
  v_mov_b32 v228, s42
  ds_write_b32 v228, v224 offset:51392
  s_waitcnt lgkmcnt(0)
  s_barrier
  v_mov_b32 v228, 0
  ds_read_b128 v[224:227], v228 offset:51392
  s_waitcnt lgkmcnt(0)
  v_max_u32 v224, v224, v225
  v_max3_u32 v224, v224, v226, v227
  s_nop 0
  v_readfirstlane_b32 s41, v224
  s_nop 3
  s_and_b32 s42, s41, 0x7ff
  s_sub_u32 s42, 2047, s42
  s_waitcnt vmcnt(0)
  s_mul_i32 s46, s3, 8192
  s_mov_b32 s45, 0
F3_WPOLL:
  buffer_load_dword v4, v11, s[32:35], s46 offen sc0 sc1
  s_waitcnt vmcnt(0)
  v_cmp_ne_u32 vcc, 1, v4
  s_nop 4
  s_cmp_eq_u64 vcc, 0
  s_cbranch_scc1 F3_WPOLL_OK
  s_add_u32 s45, s45, 1
  s_cmp_lt_u32 s45, 20000
  s_cbranch_scc1 F3_WPOLL
F3_WPOLL_OK:
  s_lshr_b32 s19, s2, 6
  s_lshl_b32 s19, s19, 5
  s_and_b32 s18, s2, 31
  s_add_u32 s19, s19, s18
  s_mul_i32 s19, s19, 32768
  s_bfe_u32 s18, s2, 0x10005
  s_lshl_b32 s18, s18, 6
  s_add_u32 s19, s19, s18
  s_lshl_b32 s18, s3, 13
  s_add_u32 s19, s19, s18
  s_lshl_b32 s18, s3, 12
  s_add_u32 m0, s18, 0
  s_nop 0
  buffer_load_dwordx4 v13, s[20:23], s19 offen sc1 lds
  s_add_u32 m0, s18, 1024
  s_add_u32 s19, s19, 2048
  buffer_load_dwordx4 v13, s[20:23], s19 offen sc1 lds
  s_add_u32 m0, s18, 2048
  s_add_u32 s19, s19, 2048
  buffer_load_dwordx4 v13, s[20:23], s19 offen sc1 lds
  s_add_u32 m0, s18, 3072
  s_add_u32 s19, s19, 2048
  buffer_load_dwordx4 v13, s[20:23], s19 offen sc1 lds
F3_HAVE:
  s_waitcnt vmcnt(0)
  s_barrier
  s_setprio 3
  ds_read_b128 v[144:147], v8 offset:0
  ds_read_b128 v[148:151], v8 offset:4096
  ds_read_b128 v[152:155], v8 offset:8192
  ds_read_b128 v[156:159], v8 offset:12288
  s_waitcnt lgkmcnt(3)
  v_mfma_f32_32x32x16_bf16 v[16:31], v[144:147], v[48:51], 0
  v_mfma_f32_32x32x16_bf16 v[32:47], v[144:147], v[64:67], 0
  s_waitcnt lgkmcnt(2)
  v_mfma_f32_32x32x16_bf16 v[16:31], v[148:151], v[52:55], v[16:31]
  v_mfma_f32_32x32x16_bf16 v[32:47], v[148:151], v[68:71], v[32:47]
  s_waitcnt lgkmcnt(1)
  v_mfma_f32_32x32x16_bf16 v[16:31], v[152:155], v[56:59], v[16:31]
  v_mfma_f32_32x32x16_bf16 v[32:47], v[152:155], v[72:75], v[32:47]
  s_waitcnt lgkmcnt(0)
  v_mfma_f32_32x32x16_bf16 v[16:31], v[156:159], v[60:63], v[16:31]
  v_mfma_f32_32x32x16_bf16 v[32:47], v[156:159], v[76:79], v[32:47]
  s_nop 10
  v_pk_mul_f32 v[4:5], v[16:17], v[80:81]
  v_pk_fma_f32 v[4:5], v[32:33], v[96:97], v[4:5]
  v_pk_mul_f32 v[32:33], v[32:33], v[80:81]
  v_pk_fma_f32 v[32:33], v[16:17], v[96:97], v[32:33] neg_lo:[1,0,0] neg_hi:[1,0,0]
  v_cvt_pk_bf16_f32 v144, v4, v32
  v_cvt_pk_bf16_f32 v145, v5, v33
  v_pk_mul_f32 v[6:7], v[18:19], v[82:83]
  v_pk_fma_f32 v[6:7], v[34:35], v[98:99], v[6:7]
  v_pk_mul_f32 v[34:35], v[34:35], v[82:83]
  v_pk_fma_f32 v[34:35], v[18:19], v[98:99], v[34:35] neg_lo:[1,0,0] neg_hi:[1,0,0]
  v_cvt_pk_bf16_f32 v146, v6, v34
  v_cvt_pk_bf16_f32 v147, v7, v35
  v_pk_mul_f32 v[14:15], v[20:21], v[84:85]
  v_pk_fma_f32 v[14:15], v[36:37], v[100:101], v[14:15]
  v_pk_mul_f32 v[36:37], v[36:37], v[84:85]
  v_pk_fma_f32 v[36:37], v[20:21], v[100:101], v[36:37] neg_lo:[1,0,0] neg_hi:[1,0,0]
  v_cvt_pk_bf16_f32 v148, v14, v36
  v_cvt_pk_bf16_f32 v149, v15, v37
  v_pk_mul_f32 v[4:5], v[22:23], v[86:87]
  v_pk_fma_f32 v[4:5], v[38:39], v[102:103], v[4:5]
  v_pk_mul_f32 v[38:39], v[38:39], v[86:87]
  v_pk_fma_f32 v[38:39], v[22:23], v[102:103], v[38:39] neg_lo:[1,0,0] neg_hi:[1,0,0]
  v_cvt_pk_bf16_f32 v150, v4, v38
  v_cvt_pk_bf16_f32 v151, v5, v39
  v_pk_mul_f32 v[6:7], v[24:25], v[88:89]
  v_pk_fma_f32 v[6:7], v[40:41], v[104:105], v[6:7]
  v_pk_mul_f32 v[40:41], v[40:41], v[88:89]
  v_pk_fma_f32 v[40:41], v[24:25], v[104:105], v[40:41] neg_lo:[1,0,0] neg_hi:[1,0,0]
  v_cvt_pk_bf16_f32 v152, v6, v40
  v_cvt_pk_bf16_f32 v153, v7, v41
  v_pk_mul_f32 v[14:15], v[26:27], v[90:91]
  v_pk_fma_f32 v[14:15], v[42:43], v[106:107], v[14:15]
  v_pk_mul_f32 v[42:43], v[42:43], v[90:91]
  v_pk_fma_f32 v[42:43], v[26:27], v[106:107], v[42:43] neg_lo:[1,0,0] neg_hi:[1,0,0]
  v_cvt_pk_bf16_f32 v154, v14, v42
  v_cvt_pk_bf16_f32 v155, v15, v43
  v_pk_mul_f32 v[4:5], v[28:29], v[92:93]
  v_pk_fma_f32 v[4:5], v[44:45], v[108:109], v[4:5]
  v_pk_mul_f32 v[44:45], v[44:45], v[92:93]
  v_pk_fma_f32 v[44:45], v[28:29], v[108:109], v[44:45] neg_lo:[1,0,0] neg_hi:[1,0,0]
  v_cvt_pk_bf16_f32 v156, v4, v44
  v_cvt_pk_bf16_f32 v157, v5, v45
  v_pk_mul_f32 v[6:7], v[30:31], v[94:95]
  v_pk_fma_f32 v[6:7], v[46:47], v[110:111], v[6:7]
  v_pk_mul_f32 v[46:47], v[46:47], v[94:95]
  v_pk_fma_f32 v[46:47], v[30:31], v[110:111], v[46:47] neg_lo:[1,0,0] neg_hi:[1,0,0]
  v_cvt_pk_bf16_f32 v158, v6, v46
  v_cvt_pk_bf16_f32 v159, v7, v47
  v_mfma_f32_32x32x16_bf16 v[16:31], v[144:147], v[48:51], 0
  v_mfma_f32_32x32x16_bf16 v[32:47], v[144:147], v[64:67], 0
  v_mfma_f32_32x32x16_bf16 v[16:31], v[148:151], v[52:55], v[16:31]
  v_mfma_f32_32x32x16_bf16 v[32:47], v[148:151], v[68:71], v[32:47]
  v_mfma_f32_32x32x16_bf16 v[16:31], v[152:155], v[56:59], v[16:31]
  v_mfma_f32_32x32x16_bf16 v[32:47], v[152:155], v[72:75], v[32:47]
  v_mfma_f32_32x32x16_bf16 v[16:31], v[156:159], v[60:63], v[16:31]
  v_mfma_f32_32x32x16_bf16 v[32:47], v[156:159], v[76:79], v[32:47]
  s_nop 10
  v_cvt_pk_bf16_f32 v224, v16, v17
  v_cvt_pk_bf16_f32 v225, v18, v19
  v_cvt_pk_bf16_f32 v226, -v32, -v33
  v_cvt_pk_bf16_f32 v227, -v34, -v35
  ds_write_b64 v9, v[224:225] offset:0
  ds_write_b64 v9, v[226:227] offset:2560
  v_cvt_pk_bf16_f32 v228, v20, v21
  v_cvt_pk_bf16_f32 v229, v22, v23
  v_cvt_pk_bf16_f32 v230, -v36, -v37
  v_cvt_pk_bf16_f32 v231, -v38, -v39
  ds_write_b64 v9, v[228:229] offset:16
  ds_write_b64 v9, v[230:231] offset:2576
  v_cvt_pk_bf16_f32 v224, v24, v25
  v_cvt_pk_bf16_f32 v225, v26, v27
  v_cvt_pk_bf16_f32 v226, -v40, -v41
  v_cvt_pk_bf16_f32 v227, -v42, -v43
  ds_write_b64 v9, v[224:225] offset:32
  ds_write_b64 v9, v[226:227] offset:2592
  v_cvt_pk_bf16_f32 v228, v28, v29
  v_cvt_pk_bf16_f32 v229, v30, v31
  v_cvt_pk_bf16_f32 v230, -v44, -v45
  v_cvt_pk_bf16_f32 v231, -v46, -v47
  ds_write_b64 v9, v[228:229] offset:48
  ds_write_b64 v9, v[230:231] offset:2608
  ds_read_b128 v[192:195], v10 offset:0
  ds_read_b128 v[196:199], v10 offset:1280
  ds_read_b128 v[200:203], v10 offset:2560
  ds_read_b128 v[204:207], v10 offset:3840
  s_waitcnt lgkmcnt(3)
  v_lshlrev_b32 v232, 16, v192
  v_and_b32 v233, s44, v192
  v_pk_fma_f32 v[160:161], v[232:233], v[112:113], v[160:161]
  v_cvt_pk_bf16_f32 v144, v160, v161
  v_lshlrev_b32 v234, 16, v193
  v_and_b32 v235, s44, v193
  v_pk_fma_f32 v[162:163], v[234:235], v[114:115], v[162:163]
  v_cvt_pk_bf16_f32 v145, v162, v163
  v_lshlrev_b32 v236, 16, v194
  v_and_b32 v237, s44, v194
  v_pk_fma_f32 v[164:165], v[236:237], v[116:117], v[164:165]
  v_cvt_pk_bf16_f32 v146, v164, v165
  v_lshlrev_b32 v238, 16, v195
  v_and_b32 v239, s44, v195
  v_pk_fma_f32 v[166:167], v[238:239], v[118:119], v[166:167]
  v_cvt_pk_bf16_f32 v147, v166, v167
  s_waitcnt lgkmcnt(2)
  v_lshlrev_b32 v232, 16, v196
  v_and_b32 v233, s44, v196
  v_pk_fma_f32 v[168:169], v[232:233], v[120:121], v[168:169]
  v_cvt_pk_bf16_f32 v148, v168, v169
  v_lshlrev_b32 v234, 16, v197
  v_and_b32 v235, s44, v197
  v_pk_fma_f32 v[170:171], v[234:235], v[122:123], v[170:171]
  v_cvt_pk_bf16_f32 v149, v170, v171
  v_lshlrev_b32 v236, 16, v198
  v_and_b32 v237, s44, v198
  v_pk_fma_f32 v[172:173], v[236:237], v[124:125], v[172:173]
  v_cvt_pk_bf16_f32 v150, v172, v173
  v_lshlrev_b32 v238, 16, v199
  v_and_b32 v239, s44, v199
  v_pk_fma_f32 v[174:175], v[238:239], v[126:127], v[174:175]
  v_cvt_pk_bf16_f32 v151, v174, v175
  s_lshl_b32 s40, s11, 1
  s_cmp_eq_u32 s40, s42
  s_cbranch_scc1 F3_SKIP0
  buffer_store_dwordx4 v[144:147], v2, s[36:39], s24 offen offset:0 sc0 sc1
  buffer_store_dwordx4 v[148:151], v2, s[36:39], s24 offen offset:1024 sc0 sc1
F3_SKIP0:
  s_waitcnt lgkmcnt(1)
  v_lshlrev_b32 v232, 16, v200
  v_and_b32 v233, s44, v200
  v_pk_fma_f32 v[176:177], v[232:233], v[128:129], v[176:177]
  v_cvt_pk_bf16_f32 v152, v176, v177
  v_lshlrev_b32 v234, 16, v201
  v_and_b32 v235, s44, v201
  v_pk_fma_f32 v[178:179], v[234:235], v[130:131], v[178:179]
  v_cvt_pk_bf16_f32 v153, v178, v179
  v_lshlrev_b32 v236, 16, v202
  v_and_b32 v237, s44, v202
  v_pk_fma_f32 v[180:181], v[236:237], v[132:133], v[180:181]
  v_cvt_pk_bf16_f32 v154, v180, v181
  v_lshlrev_b32 v238, 16, v203
  v_and_b32 v239, s44, v203
  v_pk_fma_f32 v[182:183], v[238:239], v[134:135], v[182:183]
  v_cvt_pk_bf16_f32 v155, v182, v183
  s_waitcnt lgkmcnt(0)
  v_lshlrev_b32 v232, 16, v204
  v_and_b32 v233, s44, v204
  v_pk_fma_f32 v[184:185], v[232:233], v[136:137], v[184:185]
  v_cvt_pk_bf16_f32 v156, v184, v185
  v_lshlrev_b32 v234, 16, v205
  v_and_b32 v235, s44, v205
  v_pk_fma_f32 v[186:187], v[234:235], v[138:139], v[186:187]
  v_cvt_pk_bf16_f32 v157, v186, v187
  v_lshlrev_b32 v236, 16, v206
  v_and_b32 v237, s44, v206
  v_pk_fma_f32 v[188:189], v[236:237], v[140:141], v[188:189]
  v_cvt_pk_bf16_f32 v158, v188, v189
  v_lshlrev_b32 v238, 16, v207
  v_and_b32 v239, s44, v207
  v_pk_fma_f32 v[190:191], v[238:239], v[142:143], v[190:191]
  v_cvt_pk_bf16_f32 v159, v190, v191
  s_lshl_b32 s40, s11, 1
  s_add_u32 s40, s40, 1
  s_cmp_eq_u32 s40, s42
  s_cbranch_scc1 F3_SKIP1
  buffer_store_dwordx4 v[152:155], v2, s[36:39], s24 offen offset:2048 sc0 sc1
  buffer_store_dwordx4 v[156:159], v2, s[36:39], s24 offen offset:3072 sc0 sc1
F3_SKIP1:
  s_endpgm
K23_M:
  s_load_dwordx2 s[4:5], s[0:1], 0
  s_load_dwordx4 s[12:15], s[0:1], 40
  s_load_dwordx2 s[16:17], s[0:1], 56
  s_load_dwordx2 s[8:9], s[0:1], 80
  s_sub_u32 s68, s2, 256
  s_lshr_b32 s69, s68, 2
  s_and_b32 s70, s68, 3
  v_lshrrev_b32 v3, 6, v0
  v_and_b32 v1, 63, v0
  v_readfirstlane_b32 s3, v3
  v_lshlrev_b32 v2, 4, v0
  v_lshrrev_b32 v4, 3, v1
  v_and_b32 v5, 7, v1
  v_bfe_u32 v6, v4, 1, 1
  v_lshlrev_b32 v6, 1, v6
  v_xor_b32 v5, v5, v6
  v_mul_u32_u24 v4, 7168, v4
  v_lshl_add_u32 v6, v5, 4, v4
  v_xor_b32 v5, 4, v5
  v_lshl_add_u32 v7, v5, 4, v4
  s_waitcnt lgkmcnt(0)
  s_add_u32 s20, s8, 0xe80000
  s_addc_u32 s21, s9, 0
  s_mov_b32 s22, 0x8000
  s_mov_b32 s23, 0x20000
  s_movk_i32 s10, 16384
  buffer_load_dwordx4 v[8:11], v2, s[20:23], s10 offen
  s_mov_b32 s24, s12
  s_mov_b32 s25, s13
  s_mov_b32 s26, 0x700000
  s_mov_b32 s27, 0x20000
  s_mov_b32 s28, s14
  s_mov_b32 s29, s15
  s_mov_b32 s30, 0x700000
  s_mov_b32 s31, 0x20000
  s_mov_b32 s32, s16
  s_mov_b32 s33, s17
  s_mov_b32 s34, 0x700000
  s_mov_b32 s35, 0x20000
  s_lshl_b32 s36, s70, 8
  s_lshl_b32 s37, s3, 6
  s_add_u32 s36, s36, s37
  s_mul_i32 s36, s36, 7168
  s_lshl_b32 s37, s69, 7
  s_add_u32 s36, s36, s37
  s_lshl_b32 s71, s3, 13
  s_mov_b32 s37, s36
  s_add_u32 m0, s71, 4096
  s_nop 0
  buffer_load_dwordx4 v6, s[24:27], s37 offen nt lds
  s_add_u32 s37, s37, 57344
  s_add_u32 m0, s71, 5120
  s_nop 0
  buffer_load_dwordx4 v7, s[24:27], s37 offen nt lds
  s_add_u32 s37, s37, 57344
  s_add_u32 m0, s71, 6144
  s_nop 0
  buffer_load_dwordx4 v6, s[24:27], s37 offen nt lds
  s_add_u32 s37, s37, 57344
  s_add_u32 m0, s71, 7168
  s_nop 0
  buffer_load_dwordx4 v7, s[24:27], s37 offen nt lds
  s_add_u32 s37, s37, 57344
  s_add_u32 m0, s71, 8192
  s_nop 0
  buffer_load_dwordx4 v6, s[24:27], s37 offen nt lds
  s_add_u32 s37, s37, 57344
  s_add_u32 m0, s71, 9216
  s_nop 0
  buffer_load_dwordx4 v7, s[24:27], s37 offen nt lds
  s_add_u32 s37, s37, 57344
  s_add_u32 m0, s71, 10240
  s_nop 0
  buffer_load_dwordx4 v6, s[24:27], s37 offen nt lds
  s_add_u32 s37, s37, 57344
  s_add_u32 m0, s71, 11264
  s_nop 0
  buffer_load_dwordx4 v7, s[24:27], s37 offen nt lds
  s_waitcnt vmcnt(8)
  v_max_u32 v8, v8, v9
  v_max3_u32 v8, v8, v10, v11
  s_nop 1
  v_max_u32_dpp v8, v8, v8 quad_perm:[1,0,3,2] row_mask:0xf bank_mask:0xf
  s_nop 1
  v_max_u32_dpp v8, v8, v8 quad_perm:[2,3,0,1] row_mask:0xf bank_mask:0xf
  s_nop 1
  v_max_u32_dpp v8, v8, v8 row_half_mirror row_mask:0xf bank_mask:0xf
  s_nop 1
  v_max_u32_dpp v8, v8, v8 row_mirror row_mask:0xf bank_mask:0xf
  v_mov_b32 v12, v8
  s_nop 1
  v_permlane16_swap_b32 v12, v8
  v_max_u32 v8, v12, v8
  v_mov_b32 v12, v8
  s_nop 1
  v_permlane32_swap_b32 v12, v8
  v_max_u32 v8, v12, v8
  s_lshl_b32 s39, s3, 2
  v_mov_b32 v12, s39
  ds_write_b32 v12, v8 offset:0
  s_waitcnt lgkmcnt(0)
  s_barrier
  v_mov_b32 v12, 0
  ds_read_b128 v[8:11], v12 offset:0
  s_waitcnt lgkmcnt(0)
  v_max_u32 v8, v8, v9
  v_max3_u32 v8, v8, v10, v11
  s_nop 0
  v_readfirstlane_b32 s38, v8
  s_nop 3
  s_and_b32 s39, s38, 0x7ff
  s_sub_u32 s39, 2047, s39
  s_mov_b32 s44, s4
  s_mov_b32 s45, s5
  s_mov_b32 s46, 0x400000
  s_mov_b32 s47, 0x20000
  s_lshl_b32 s40, s39, 11
  s_lshl_b32 s41, s70, 9
  s_add_u32 s40, s40, s41
  s_lshl_b32 s41, s3, 7
  s_add_u32 s40, s40, s41
  v_lshlrev_b32 v13, 1, v1
  buffer_load_ushort v14, v13, s[44:47], s40 offen
  s_lshl_b32 s41, s39, 3
  v_mov_b32 v9, 0
  buffer_load_dwordx2 v[10:11], v9, s[20:23], s41 offen
  s_mov_b32 s37, s36
  s_add_u32 m0, s71, 36864
  s_nop 0
  buffer_load_dwordx4 v6, s[28:31], s37 offen nt lds
  s_add_u32 s37, s37, 57344
  s_add_u32 m0, s71, 37888
  s_nop 0
  buffer_load_dwordx4 v7, s[28:31], s37 offen nt lds
  s_add_u32 s37, s37, 57344
  s_add_u32 m0, s71, 38912
  s_nop 0
  buffer_load_dwordx4 v6, s[28:31], s37 offen nt lds
  s_add_u32 s37, s37, 57344
  s_add_u32 m0, s71, 39936
  s_nop 0
  buffer_load_dwordx4 v7, s[28:31], s37 offen nt lds
  s_add_u32 s37, s37, 57344
  s_add_u32 m0, s71, 40960
  s_nop 0
  buffer_load_dwordx4 v6, s[28:31], s37 offen nt lds
  s_add_u32 s37, s37, 57344
  s_add_u32 m0, s71, 41984
  s_nop 0
  buffer_load_dwordx4 v7, s[28:31], s37 offen nt lds
  s_add_u32 s37, s37, 57344
  s_add_u32 m0, s71, 43008
  s_nop 0
  buffer_load_dwordx4 v6, s[28:31], s37 offen nt lds
  s_add_u32 s37, s37, 57344
  s_add_u32 m0, s71, 44032
  s_nop 0
  buffer_load_dwordx4 v7, s[28:31], s37 offen nt lds
  v_and_b32 v16, 15, v1
  v_lshrrev_b32 v17, 4, v1
  v_lshrrev_b32 v18, 2, v16
  v_and_b32 v19, 3, v16
  v_lshl_add_u32 v20, v17, 3, v18
  v_lshlrev_b32 v20, 7, v20
  v_lshlrev_b32 v21, 3, v19
  v_add3_u32 v20, v20, v21, s71
  v_bfe_u32 v21, v18, 1, 1
  v_and_b32 v22, 1, v17
  v_lshl_add_u32 v21, v22, 1, v21
  v_xor_b32 v22, 0, v21
  v_lshl_add_u32 v24, v22, 5, v20
  v_xor_b32 v22, 1, v21
  v_lshl_add_u32 v25, v22, 5, v20
  v_xor_b32 v22, 2, v21
  v_lshl_add_u32 v26, v22, 5, v20
  v_xor_b32 v22, 3, v21
  v_lshl_add_u32 v27, v22, 5, v20
  s_waitcnt vmcnt(9)
  v_lshlrev_b32 v14, 16, v14
  s_waitcnt vmcnt(8)
  v_fma_f32 v14, v14, v10, v11
  v_cvt_pk_bf16_f32 v14, v14, v14
  s_lshl_b32 s41, s3, 7
  v_add_u32 v13, s41, v13
  ds_write_b16 v13, v14 offset:128
  v_lshlrev_b32 v15, 4, v17
  v_add_u32 v15, s41, v15
  ds_read_b128 v[32:35], v15 offset:128
  ds_read_b128 v[36:39], v15 offset:192
  ds_read_b64_tr_b16 v[96:97], v24 offset:4096
  ds_read_b64_tr_b16 v[98:99], v24 offset:4608
  ds_read_b64_tr_b16 v[100:101], v24 offset:8192
  ds_read_b64_tr_b16 v[102:103], v24 offset:8704
  ds_read_b64_tr_b16 v[104:105], v25 offset:4096
  ds_read_b64_tr_b16 v[106:107], v25 offset:4608
  ds_read_b64_tr_b16 v[108:109], v25 offset:8192
  ds_read_b64_tr_b16 v[110:111], v25 offset:8704
  ds_read_b64_tr_b16 v[112:113], v26 offset:4096
  ds_read_b64_tr_b16 v[114:115], v26 offset:4608
  ds_read_b64_tr_b16 v[116:117], v26 offset:8192
  ds_read_b64_tr_b16 v[118:119], v26 offset:8704
  ds_read_b64_tr_b16 v[120:121], v27 offset:4096
  ds_read_b64_tr_b16 v[122:123], v27 offset:4608
  ds_read_b64_tr_b16 v[124:125], v27 offset:8192
  ds_read_b64_tr_b16 v[126:127], v27 offset:8704
  s_waitcnt lgkmcnt(14)
  v_mfma_f32_16x16x32_bf16 v[48:51], v[32:35], v[96:99], 0
  s_waitcnt lgkmcnt(12)
  v_mfma_f32_16x16x32_bf16 v[48:51], v[36:39], v[100:103], v[48:51]
  s_waitcnt lgkmcnt(10)
  v_mfma_f32_16x16x32_bf16 v[52:55], v[32:35], v[104:107], 0
  s_waitcnt lgkmcnt(8)
  v_mfma_f32_16x16x32_bf16 v[52:55], v[36:39], v[108:111], v[52:55]
  s_waitcnt lgkmcnt(6)
  v_mfma_f32_16x16x32_bf16 v[56:59], v[32:35], v[112:115], 0
  s_waitcnt lgkmcnt(4)
  v_mfma_f32_16x16x32_bf16 v[56:59], v[36:39], v[116:119], v[56:59]
  s_waitcnt lgkmcnt(2)
  v_mfma_f32_16x16x32_bf16 v[60:63], v[32:35], v[120:123], 0
  s_waitcnt lgkmcnt(0)
  v_mfma_f32_16x16x32_bf16 v[60:63], v[36:39], v[124:127], v[60:63]
  s_waitcnt vmcnt(0)
  ds_read_b64_tr_b16 v[96:97], v24 offset:36864
  ds_read_b64_tr_b16 v[98:99], v24 offset:37376
  ds_read_b64_tr_b16 v[100:101], v24 offset:40960
  ds_read_b64_tr_b16 v[102:103], v24 offset:41472
  ds_read_b64_tr_b16 v[104:105], v25 offset:36864
  ds_read_b64_tr_b16 v[106:107], v25 offset:37376
  ds_read_b64_tr_b16 v[108:109], v25 offset:40960
  ds_read_b64_tr_b16 v[110:111], v25 offset:41472
  ds_read_b64_tr_b16 v[112:113], v26 offset:36864
  ds_read_b64_tr_b16 v[114:115], v26 offset:37376
  ds_read_b64_tr_b16 v[116:117], v26 offset:40960
  ds_read_b64_tr_b16 v[118:119], v26 offset:41472
  ds_read_b64_tr_b16 v[120:121], v27 offset:36864
  ds_read_b64_tr_b16 v[122:123], v27 offset:37376
  ds_read_b64_tr_b16 v[124:125], v27 offset:40960
  ds_read_b64_tr_b16 v[126:127], v27 offset:41472
  s_waitcnt lgkmcnt(14)
  v_mfma_f32_16x16x32_bf16 v[64:67], v[32:35], v[96:99], 0
  s_waitcnt lgkmcnt(12)
  v_mfma_f32_16x16x32_bf16 v[64:67], v[36:39], v[100:103], v[64:67]
  s_waitcnt lgkmcnt(10)
  v_mfma_f32_16x16x32_bf16 v[68:71], v[32:35], v[104:107], 0
  s_waitcnt lgkmcnt(8)
  v_mfma_f32_16x16x32_bf16 v[68:71], v[36:39], v[108:111], v[68:71]
  s_waitcnt lgkmcnt(6)
  v_mfma_f32_16x16x32_bf16 v[72:75], v[32:35], v[112:115], 0
  s_waitcnt lgkmcnt(4)
  v_mfma_f32_16x16x32_bf16 v[72:75], v[36:39], v[116:119], v[72:75]
  s_waitcnt lgkmcnt(2)
  v_mfma_f32_16x16x32_bf16 v[76:79], v[32:35], v[120:123], 0
  s_waitcnt lgkmcnt(0)
  v_mfma_f32_16x16x32_bf16 v[76:79], v[36:39], v[124:127], v[76:79]
  v_and_b32 v13, 15, v1
  v_lshlrev_b32 v13, 2, v13
  s_lshl_b32 s41, s3, 9
  v_add_u32 v13, s41, v13
  s_mov_b64 exec, 0xffff
  ds_write_b32 v13, v48 offset:1024
  ds_write_b32 v13, v52 offset:1088
  ds_write_b32 v13, v56 offset:1152
  ds_write_b32 v13, v60 offset:1216
  ds_write_b32 v13, v64 offset:1280
  ds_write_b32 v13, v68 offset:1344
  ds_write_b32 v13, v72 offset:1408
  ds_write_b32 v13, v76 offset:1472
  s_mov_b64 exec, -1
  s_cmp_lt_u32 s3, 2
  s_cbranch_scc0 M_HI
  s_waitcnt lgkmcnt(0)
  s_barrier
  s_add_u32 s44, s8, 0xde0000
  s_addc_u32 s45, s9, 0
  s_mov_b32 s46, 0x1c000
  s_mov_b32 s47, 0x20000
  v_lshlrev_b32 v12, 2, v1
  s_lshl_b32 s11, s3, 8
  v_add_u32 v9, s11, v12
  ds_read_b32 v16, v9 offset:1024
  ds_read_b32 v17, v9 offset:1536
  ds_read_b32 v18, v9 offset:2048
  ds_read_b32 v19, v9 offset:2560
  s_lshl_b32 s37, s70, 1
  s_add_u32 s37, s37, s3
  s_mul_i32 s37, s37, 14336
  s_lshl_b32 s38, s69, 8
  s_add_u32 s37, s37, s38
  s_waitcnt lgkmcnt(2)
  v_add_f32 v16, v16, v17
  s_waitcnt lgkmcnt(0)
  v_add_f32 v18, v18, v19
  v_add_f32 v16, v16, v18
  v_min_u32 v16, -2, v16
  buffer_store_dword v16, v12, s[44:47], s37 offen sc0 sc1
  s_cmp_eq_u32 s3, 0
  s_cbranch_scc0 M_W1
  s_mov_b32 s48, 0xffff0000
  v_lshrrev_b32 v4, 4, v1
  v_mul_u32_u24 v4, 28672, v4
  v_and_b32 v5, 15, v1
  v_lshlrev_b32 v5, 2, v5
  v_add_u32 v4, v4, v5
  s_lshl_b32 s10, s68, 6
  s_add_u32 s11, s10, 14336
  s_mov_b32 s49, 0
M_POLL:
  buffer_load_dword v8, v4, s[44:47], s10 offen sc0 sc1
  buffer_load_dword v9, v4, s[44:47], s11 offen sc0 sc1
  s_waitcnt vmcnt(0)
  v_max_u32 v10, v8, v9
  v_cmp_eq_u32 vcc, -1, v10
  s_nop 4
  s_cmp_eq_u64 vcc, 0
  s_cbranch_scc1 M_POLL_OK
  s_add_u32 s49, s49, 1
  s_cmp_lt_u32 s49, 20000
  s_cbranch_scc1 M_POLL
M_POLL_OK:
  v_mov_b32 v10, v8
  v_mov_b32 v11, v9
  s_nop 0
  v_permlane16_swap_b32 v10, v8
  v_permlane16_swap_b32 v11, v9
  v_add_f32 v8, v8, v10
  v_add_f32 v9, v9, v11
  v_mov_b32 v10, v8
  v_mov_b32 v11, v9
  s_nop 0
  v_permlane32_swap_b32 v10, v8
  v_permlane32_swap_b32 v11, v9
  v_add_f32 v8, v8, v10
  v_add_f32 v9, v9, v11
  v_cvt_pk_bf16_f32 v13, v8, v9
  v_lshlrev_b32 v12, 16, v13
  v_and_b32 v13, s48, v13
  v_mul_f32 v14, 0xbfb8aa3b, v12
  v_exp_f32 v14, v14
  s_nop 0
  v_add_f32 v14, 1.0, v14
  v_rcp_f32 v14, v14
  s_nop 0
  v_mul_f32 v12, v12, v14
  v_cvt_pk_bf16_f32 v12, v12, v12
  v_lshlrev_b32 v12, 16, v12
  v_mul_f32 v12, v12, v13
  v_cvt_pk_bf16_f32 v12, v12, v12
  v_lshlrev_b32 v4, 1, v1
  s_mov_b64 exec, 0xffff
  ds_write_b16 v4, v12 offset:64
  s_mov_b64 exec, -1
  s_waitcnt lgkmcnt(0)
M_W1:
  s_barrier
  s_endpgm
M_HI:
  s_waitcnt lgkmcnt(0)
  s_barrier
  s_sub_u32 s11, s3, 2
  s_lshl_b32 s37, s68, 15
  s_lshl_b32 s38, s11, 10
  s_add_u32 s37, s37, s38
  s_lshl_b32 s71, s11, 14
  v_lshlrev_b32 v2, 4, v1
  v_xor_b32 v4, 0, v2
  s_add_u32 m0, s71, 4096
  s_nop 0
  buffer_load_dwordx4 v4, s[32:35], s37 offen nt lds
  s_add_u32 s37, s37, 2048
  v_xor_b32 v5, 32, v2
  s_add_u32 m0, s71, 5120
  s_nop 0
  buffer_load_dwordx4 v5, s[32:35], s37 offen nt lds
  s_add_u32 s37, s37, 2048
  v_xor_b32 v4, 64, v2
  s_add_u32 m0, s71, 6144
  s_nop 0
  buffer_load_dwordx4 v4, s[32:35], s37 offen nt lds
  s_add_u32 s37, s37, 2048
  v_xor_b32 v5, 96, v2
  s_add_u32 m0, s71, 7168
  s_nop 0
  buffer_load_dwordx4 v5, s[32:35], s37 offen nt lds
  s_add_u32 s37, s37, 2048
  v_xor_b32 v4, 128, v2
  s_add_u32 m0, s71, 8192
  s_nop 0
  buffer_load_dwordx4 v4, s[32:35], s37 offen nt lds
  s_add_u32 s37, s37, 2048
  v_xor_b32 v5, 160, v2
  s_add_u32 m0, s71, 9216
  s_nop 0
  buffer_load_dwordx4 v5, s[32:35], s37 offen nt lds
  s_add_u32 s37, s37, 2048
  v_xor_b32 v4, 192, v2
  s_add_u32 m0, s71, 10240
  s_nop 0
  buffer_load_dwordx4 v4, s[32:35], s37 offen nt lds
  s_add_u32 s37, s37, 2048
  v_xor_b32 v5, 224, v2
  s_add_u32 m0, s71, 11264
  s_nop 0
  buffer_load_dwordx4 v5, s[32:35], s37 offen nt lds
  s_add_u32 s37, s37, 2048
  v_xor_b32 v4, 0, v2
  s_add_u32 m0, s71, 12288
  s_nop 0
  buffer_load_dwordx4 v4, s[32:35], s37 offen nt lds
  s_add_u32 s37, s37, 2048
  v_xor_b32 v5, 32, v2
  s_add_u32 m0, s71, 13312
  s_nop 0
  buffer_load_dwordx4 v5, s[32:35], s37 offen nt lds
  s_add_u32 s37, s37, 2048
  v_xor_b32 v4, 64, v2
  s_add_u32 m0, s71, 14336
  s_nop 0
  buffer_load_dwordx4 v4, s[32:35], s37 offen nt lds
  s_add_u32 s37, s37, 2048
  v_xor_b32 v5, 96, v2
  s_add_u32 m0, s71, 15360
  s_nop 0
  buffer_load_dwordx4 v5, s[32:35], s37 offen nt lds
  s_add_u32 s37, s37, 2048
  v_xor_b32 v4, 128, v2
  s_add_u32 m0, s71, 16384
  s_nop 0
  buffer_load_dwordx4 v4, s[32:35], s37 offen nt lds
  s_add_u32 s37, s37, 2048
  v_xor_b32 v5, 160, v2
  s_add_u32 m0, s71, 17408
  s_nop 0
  buffer_load_dwordx4 v5, s[32:35], s37 offen nt lds
  s_add_u32 s37, s37, 2048
  v_xor_b32 v4, 192, v2
  s_add_u32 m0, s71, 18432
  s_nop 0
  buffer_load_dwordx4 v4, s[32:35], s37 offen nt lds
  s_add_u32 s37, s37, 2048
  v_xor_b32 v5, 224, v2
  s_add_u32 m0, s71, 19456
  s_nop 0
  buffer_load_dwordx4 v5, s[32:35], s37 offen nt lds
  v_and_b32 v16, 15, v1
  v_lshrrev_b32 v17, 4, v1
  v_lshrrev_b32 v18, 2, v16
  v_and_b32 v19, 3, v16
  v_lshl_add_u32 v20, v17, 2, v18
  v_and_b32 v21, 7, v20
  v_lshlrev_b32 v20, 10, v20
  v_lshlrev_b32 v22, 3, v19
  v_add3_u32 v20, v20, v22, s71
  v_xor_b32 v22, 0, v21
  v_lshl_add_u32 v24, v22, 5, v20
  v_xor_b32 v22, 1, v21
  v_lshl_add_u32 v25, v22, 5, v20
  v_xor_b32 v22, 2, v21
  v_lshl_add_u32 v26, v22, 5, v20
  v_xor_b32 v22, 3, v21
  v_lshl_add_u32 v27, v22, 5, v20
  v_xor_b32 v22, 4, v21
  v_lshl_add_u32 v28, v22, 5, v20
  v_xor_b32 v22, 5, v21
  v_lshl_add_u32 v29, v22, 5, v20
  v_xor_b32 v22, 6, v21
  v_lshl_add_u32 v30, v22, 5, v20
  v_xor_b32 v22, 7, v21
  v_lshl_add_u32 v31, v22, 5, v20
  v_lshlrev_b32 v15, 3, v17
  s_mov_b32 s52, 0xffff0000
  s_mov_b32 s53, 0
  s_mov_b32 s54, 0
  s_mov_b32 s55, 0x0000ffff
  s_mov_b32 s56, 0
  s_mov_b32 s57, 0xffff0000
  s_add_u32 s44, s8, 0xd00000
  s_addc_u32 s45, s9, 0
  s_mov_b32 s46, 0xe0000
  s_mov_b32 s47, 0x20000
  s_lshl_b32 s38, s68, 12
  s_lshl_b32 s39, s11, 11
  s_add_u32 s38, s38, s39
  v_lshlrev_b32 v9, 2, v1
  s_waitcnt vmcnt(0)
  s_barrier
  ds_read_b64 v[32:33], v15 offset:64
  ds_read_b64_tr_b16 v[64:65], v24 offset:4096
  ds_read_b64_tr_b16 v[66:67], v25 offset:4096
  ds_read_b64_tr_b16 v[68:69], v26 offset:4096
  ds_read_b64_tr_b16 v[70:71], v27 offset:4096
  ds_read_b64_tr_b16 v[72:73], v28 offset:4096
  ds_read_b64_tr_b16 v[74:75], v29 offset:4096
  ds_read_b64_tr_b16 v[76:77], v30 offset:4096
  ds_read_b64_tr_b16 v[78:79], v31 offset:4096
  ds_read_b64_tr_b16 v[80:81], v24 offset:4352
  ds_read_b64_tr_b16 v[82:83], v25 offset:4352
  ds_read_b64_tr_b16 v[84:85], v26 offset:4352
  ds_read_b64_tr_b16 v[86:87], v27 offset:4352
  ds_read_b64_tr_b16 v[88:89], v28 offset:4352
  ds_read_b64_tr_b16 v[90:91], v29 offset:4352
  ds_read_b64_tr_b16 v[92:93], v30 offset:4352
  ds_read_b64_tr_b16 v[94:95], v31 offset:4352
  ds_read_b64_tr_b16 v[96:97], v24 offset:4608
  ds_read_b64_tr_b16 v[98:99], v25 offset:4608
  ds_read_b64_tr_b16 v[100:101], v26 offset:4608
  ds_read_b64_tr_b16 v[102:103], v27 offset:4608
  ds_read_b64_tr_b16 v[104:105], v28 offset:4608
  ds_read_b64_tr_b16 v[106:107], v29 offset:4608
  ds_read_b64_tr_b16 v[108:109], v30 offset:4608
  ds_read_b64_tr_b16 v[110:111], v31 offset:4608
  ds_read_b64_tr_b16 v[112:113], v24 offset:4864
  ds_read_b64_tr_b16 v[114:115], v25 offset:4864
  ds_read_b64_tr_b16 v[116:117], v26 offset:4864
  ds_read_b64_tr_b16 v[118:119], v27 offset:4864
  ds_read_b64_tr_b16 v[120:121], v28 offset:4864
  ds_read_b64_tr_b16 v[122:123], v29 offset:4864
  ds_read_b64_tr_b16 v[124:125], v30 offset:4864
  ds_read_b64_tr_b16 v[126:127], v31 offset:4864
  s_waitcnt lgkmcnt(15)
  v_mfma_f32_16x16x16_bf16 v[128:131], v[32:33], v[64:65], 0
  v_mfma_f32_16x16x16_bf16 v[132:135], v[32:33], v[66:67], 0
  v_mfma_f32_16x16x16_bf16 v[136:139], v[32:33], v[68:69], 0
  v_mfma_f32_16x16x16_bf16 v[140:143], v[32:33], v[70:71], 0
  v_mfma_f32_16x16x16_bf16 v[144:147], v[32:33], v[72:73], 0
  v_mfma_f32_16x16x16_bf16 v[148:151], v[32:33], v[74:75], 0
  v_mfma_f32_16x16x16_bf16 v[152:155], v[32:33], v[76:77], 0
  v_mfma_f32_16x16x16_bf16 v[156:159], v[32:33], v[78:79], 0
  s_nop 1
  v_cndmask_b32 v40, v128, v132, s[52:53]
  v_cndmask_b32 v40, v40, v136, s[54:55]
  v_cndmask_b32 v40, v40, v140, s[56:57]
  v_min_u32 v40, -2, v40
  buffer_store_dword v40, v9, s[44:47], s38 offen offset:0 sc0 sc1
  v_mfma_f32_16x16x16_bf16 v[160:163], v[32:33], v[80:81], 0
  v_mfma_f32_16x16x16_bf16 v[164:167], v[32:33], v[82:83], 0
  v_mfma_f32_16x16x16_bf16 v[168:171], v[32:33], v[84:85], 0
  v_mfma_f32_16x16x16_bf16 v[172:175], v[32:33], v[86:87], 0
  v_cndmask_b32 v41, v144, v148, s[52:53]
  v_cndmask_b32 v41, v41, v152, s[54:55]
  v_cndmask_b32 v41, v41, v156, s[56:57]
  v_min_u32 v41, -2, v41
  buffer_store_dword v41, v9, s[44:47], s38 offen offset:256 sc0 sc1
  v_mfma_f32_16x16x16_bf16 v[176:179], v[32:33], v[88:89], 0
  v_mfma_f32_16x16x16_bf16 v[180:183], v[32:33], v[90:91], 0
  v_mfma_f32_16x16x16_bf16 v[184:187], v[32:33], v[92:93], 0
  v_mfma_f32_16x16x16_bf16 v[188:191], v[32:33], v[94:95], 0
  v_cndmask_b32 v42, v160, v164, s[52:53]
  v_cndmask_b32 v42, v42, v168, s[54:55]
  v_cndmask_b32 v42, v42, v172, s[56:57]
  v_min_u32 v42, -2, v42
  buffer_store_dword v42, v9, s[44:47], s38 offen offset:512 sc0 sc1
  v_mfma_f32_16x16x16_bf16 v[128:131], v[32:33], v[96:97], 0
  s_waitcnt lgkmcnt(14)
  v_mfma_f32_16x16x16_bf16 v[132:135], v[32:33], v[98:99], 0
  s_waitcnt lgkmcnt(13)
  v_mfma_f32_16x16x16_bf16 v[136:139], v[32:33], v[100:101], 0
  s_waitcnt lgkmcnt(12)
  v_mfma_f32_16x16x16_bf16 v[140:143], v[32:33], v[102:103], 0
  v_cndmask_b32 v43, v176, v180, s[52:53]
  v_cndmask_b32 v43, v43, v184, s[54:55]
  v_cndmask_b32 v43, v43, v188, s[56:57]
  v_min_u32 v43, -2, v43
  buffer_store_dword v43, v9, s[44:47], s38 offen offset:768 sc0 sc1
  s_waitcnt lgkmcnt(11)
  v_mfma_f32_16x16x16_bf16 v[144:147], v[32:33], v[104:105], 0
  s_waitcnt lgkmcnt(10)
  v_mfma_f32_16x16x16_bf16 v[148:151], v[32:33], v[106:107], 0
  s_waitcnt lgkmcnt(9)
  v_mfma_f32_16x16x16_bf16 v[152:155], v[32:33], v[108:109], 0
  s_waitcnt lgkmcnt(8)
  v_mfma_f32_16x16x16_bf16 v[156:159], v[32:33], v[110:111], 0
  v_cndmask_b32 v40, v128, v132, s[52:53]
  v_cndmask_b32 v40, v40, v136, s[54:55]
  v_cndmask_b32 v40, v40, v140, s[56:57]
  v_min_u32 v40, -2, v40
  buffer_store_dword v40, v9, s[44:47], s38 offen offset:1024 sc0 sc1
  s_waitcnt lgkmcnt(7)
  v_mfma_f32_16x16x16_bf16 v[160:163], v[32:33], v[112:113], 0
  s_waitcnt lgkmcnt(6)
  v_mfma_f32_16x16x16_bf16 v[164:167], v[32:33], v[114:115], 0
  s_waitcnt lgkmcnt(5)
  v_mfma_f32_16x16x16_bf16 v[168:171], v[32:33], v[116:117], 0
  s_waitcnt lgkmcnt(4)
  v_mfma_f32_16x16x16_bf16 v[172:175], v[32:33], v[118:119], 0
  v_cndmask_b32 v41, v144, v148, s[52:53]
  v_cndmask_b32 v41, v41, v152, s[54:55]
  v_cndmask_b32 v41, v41, v156, s[56:57]
  v_min_u32 v41, -2, v41
  buffer_store_dword v41, v9, s[44:47], s38 offen offset:1280 sc0 sc1
  s_waitcnt lgkmcnt(3)
  v_mfma_f32_16x16x16_bf16 v[176:179], v[32:33], v[120:121], 0
  s_waitcnt lgkmcnt(2)
  v_mfma_f32_16x16x16_bf16 v[180:183], v[32:33], v[122:123], 0
  s_waitcnt lgkmcnt(1)
  v_mfma_f32_16x16x16_bf16 v[184:187], v[32:33], v[124:125], 0
  s_waitcnt lgkmcnt(0)
  v_mfma_f32_16x16x16_bf16 v[188:191], v[32:33], v[126:127], 0
  v_cndmask_b32 v42, v160, v164, s[52:53]
  v_cndmask_b32 v42, v42, v168, s[54:55]
  v_cndmask_b32 v42, v42, v172, s[56:57]
  v_min_u32 v42, -2, v42
  buffer_store_dword v42, v9, s[44:47], s38 offen offset:1536 sc0 sc1
  v_cndmask_b32 v43, v176, v180, s[52:53]
  v_cndmask_b32 v43, v43, v184, s[54:55]
  s_nop 0
  v_cndmask_b32 v43, v43, v188, s[56:57]
  v_min_u32 v43, -2, v43
  buffer_store_dword v43, v9, s[44:47], s38 offen offset:1792 sc0 sc1
  s_endpgm
K23_S:
  s_load_dwordx2 s[4:5], s[0:1], 0
  s_load_dwordx2 s[6:7], s[0:1], 64
  s_load_dwordx2 s[8:9], s[0:1], 80
  s_sub_u32 s68, s2, 480
  v_lshrrev_b32 v3, 6, v0
  v_and_b32 v1, 63, v0
  v_readfirstlane_b32 s3, v3
  v_lshlrev_b32 v2, 4, v0
  s_waitcnt lgkmcnt(0)
  s_add_u32 s20, s8, 0xe80000
  s_addc_u32 s21, s9, 0
  s_mov_b32 s22, 0x8000
  s_mov_b32 s23, 0x20000
  s_movk_i32 s10, 16384
  buffer_load_dwordx4 v[8:11], v2, s[20:23], s10 offen
  s_add_u32 s12, s8, 0xd00000
  s_addc_u32 s13, s9, 0
  s_mov_b32 s14, 0xe0000
  s_mov_b32 s15, 0x20000
  s_add_u32 s16, s8, 0x1800000
  s_addc_u32 s17, s9, 0
  s_mov_b32 s18, 0x400000
  s_mov_b32 s19, 0x20000
  s_add_u32 s32, s8, 0xdfc000
  s_addc_u32 s33, s9, 0
  s_mov_b32 s34, 0x8000
  s_mov_b32 s35, 0x20000
  s_mov_b32 s40, s4
  s_mov_b32 s41, s5
  s_mov_b32 s42, 0x400000
  s_mov_b32 s43, 0x20000
  s_mov_b32 s36, s6
  s_mov_b32 s37, s7
  s_mov_b32 s38, 0x400000
  s_mov_b32 s39, 0x20000
  s_waitcnt vmcnt(0)
  v_max_u32 v8, v8, v9
  v_max3_u32 v8, v8, v10, v11
  s_nop 1
  v_max_u32_dpp v8, v8, v8 quad_perm:[1,0,3,2] row_mask:0xf bank_mask:0xf
  s_nop 1
  v_max_u32_dpp v8, v8, v8 quad_perm:[2,3,0,1] row_mask:0xf bank_mask:0xf
  s_nop 1
  v_max_u32_dpp v8, v8, v8 row_half_mirror row_mask:0xf bank_mask:0xf
  s_nop 1
  v_max_u32_dpp v8, v8, v8 row_mirror row_mask:0xf bank_mask:0xf
  v_mov_b32 v12, v8
  s_nop 1
  v_permlane16_swap_b32 v12, v8
  v_max_u32 v8, v12, v8
  v_mov_b32 v12, v8
  s_nop 1
  v_permlane32_swap_b32 v12, v8
  v_max_u32 v8, v12, v8
  s_lshl_b32 s61, s3, 2
  v_mov_b32 v12, s61
  ds_write_b32 v12, v8 offset:0
  s_waitcnt lgkmcnt(0)
  s_barrier
  v_mov_b32 v12, 0
  ds_read_b128 v[8:11], v12 offset:0
  s_waitcnt lgkmcnt(0)
  v_max_u32 v8, v8, v9
  v_max3_u32 v8, v8, v10, v11
  s_nop 0
  v_readfirstlane_b32 s60, v8
  s_nop 3
  s_and_b32 s61, s60, 0x7ff
  s_sub_u32 s61, 2047, s61
  s_cmp_eq_u32 s3, 0
  s_cbranch_scc0 S_WAIT
  s_lshl_b32 s24, s61, 11
  s_lshl_b32 s25, s68, 6
  s_add_u32 s24, s24, s25
  v_and_b32 v6, 31, v1
  v_lshlrev_b32 v7, 1, v6
  buffer_load_ushort v160, v7, s[40:43], s24 offen
  s_lshl_b32 s25, s61, 3
  v_mov_b32 v5, 0
  buffer_load_dwordx2 v[162:163], v5, s[20:23], s25 offen
  s_lshr_b32 s62, s60, 16
  s_and_b32 s63, s62, 0x8000
  s_cmp_lg_u32 s63, 0
  s_mov_b32 s64, 0xffff
  s_cselect_b32 s63, 0x8000, s64
  s_xor_b32 s62, s62, s63
  s_lshl_b32 s62, s62, 16
  v_mov_b32 v164, s62
  v_mul_f32 v164, 0xbfb8aa3b, v164
  v_exp_f32 v164, v164
  s_nop 0
  v_add_f32 v164, 1.0, v164
  v_rcp_f32 v164, v164
  s_nop 0
  v_cvt_pk_bf16_f32 v164, v164, v164
  v_lshlrev_b32 v164, 16, v164
  v_and_b32 v8, 31, v1
  v_cvt_f32_u32 v8, v8
  v_lshrrev_b32 v9, 5, v1
  v_cvt_f32_u32 v9, v9
  v_mul_f32 v8, 0x3d000000, v8
  v_mul_f32 v9, 4.0, v9
  v_mul_f32_e64 v9, v8, v9
  v_fmamk_f32 v32, v8, 0x00000000, v9
  v_fmamk_f32 v33, v8, 0x3f800000, v9
  v_fmamk_f32 v34, v8, 0x40000000, v9
  v_fmamk_f32 v35, v8, 0x40400000, v9
  v_fmamk_f32 v36, v8, 0x41000000, v9
  v_fmamk_f32 v37, v8, 0x41100000, v9
  v_fmamk_f32 v38, v8, 0x41200000, v9
  v_fmamk_f32 v39, v8, 0x41300000, v9
  v_fmamk_f32 v40, v8, 0x41800000, v9
  v_fmamk_f32 v41, v8, 0x41880000, v9
  v_fmamk_f32 v42, v8, 0x41900000, v9
  v_fmamk_f32 v43, v8, 0x41980000, v9
  v_fmamk_f32 v44, v8, 0x41c00000, v9
  v_fmamk_f32 v45, v8, 0x41c80000, v9
  v_fmamk_f32 v46, v8, 0x41d00000, v9
  v_fmamk_f32 v47, v8, 0x41d80000, v9
  v_mul_f32 v96, 0x3d000000, v32
  v_mul_f32 v97, 0x3d000000, v33
  v_mul_f32 v98, 0x3d000000, v34
  v_mul_f32 v99, 0x3d000000, v35
  v_mul_f32 v100, 0x3d000000, v36
  v_mul_f32 v101, 0x3d000000, v37
  v_mul_f32 v102, 0x3d000000, v38
  v_mul_f32 v103, 0x3d000000, v39
  v_mul_f32 v104, 0x3d000000, v40
  v_mul_f32 v105, 0x3d000000, v41
  v_mul_f32 v106, 0x3d000000, v42
  v_mul_f32 v107, 0x3d000000, v43
  v_mul_f32 v108, 0x3d000000, v44
  v_mul_f32 v109, 0x3d000000, v45
  v_mul_f32 v110, 0x3d000000, v46
  v_mul_f32 v111, 0x3d000000, v47
  v_cos_f32 v80, v96
  v_cos_f32 v81, v97
  v_cos_f32 v82, v98
  v_cos_f32 v83, v99
  v_cos_f32 v84, v100
  v_cos_f32 v85, v101
  v_cos_f32 v86, v102
  v_cos_f32 v87, v103
  v_cos_f32 v88, v104
  v_cos_f32 v89, v105
  v_cos_f32 v90, v106
  v_cos_f32 v91, v107
  v_cos_f32 v92, v108
  v_cos_f32 v93, v109
  v_cos_f32 v94, v110
  v_cos_f32 v95, v111
  v_sin_f32 v96, v96
  v_sin_f32 v97, v97
  v_sin_f32 v98, v98
  v_sin_f32 v99, v99
  v_sin_f32 v100, v100
  v_sin_f32 v101, v101
  v_sin_f32 v102, v102
  v_sin_f32 v103, v103
  v_sin_f32 v104, v104
  v_sin_f32 v105, v105
  v_sin_f32 v106, v106
  v_sin_f32 v107, v107
  v_sin_f32 v108, v108
  v_sin_f32 v109, v109
  v_sin_f32 v110, v110
  v_sin_f32 v111, v111
  v_cos_f32 v16, v32
  v_cos_f32 v17, v33
  v_cos_f32 v18, v34
  v_cos_f32 v19, v35
  v_cos_f32 v20, v36
  v_cos_f32 v21, v37
  v_cos_f32 v22, v38
  v_cos_f32 v23, v39
  v_cos_f32 v24, v40
  v_cos_f32 v25, v41
  v_cos_f32 v26, v42
  v_cos_f32 v27, v43
  v_cos_f32 v28, v44
  v_cos_f32 v29, v45
  v_cos_f32 v30, v46
  v_cos_f32 v31, v47
  v_sin_f32 v32, v32
  v_sin_f32 v33, v33
  v_sin_f32 v34, v34
  v_sin_f32 v35, v35
  v_sin_f32 v36, v36
  v_sin_f32 v37, v37
  v_sin_f32 v38, v38
  v_sin_f32 v39, v39
  v_sin_f32 v40, v40
  v_sin_f32 v41, v41
  v_sin_f32 v42, v42
  v_sin_f32 v43, v43
  v_sin_f32 v44, v44
  v_sin_f32 v45, v45
  v_sin_f32 v46, v46
  v_sin_f32 v47, v47
  v_cvt_pk_bf16_f32 v48, v16, v32
  v_cvt_pk_bf16_f32 v49, v17, v33
  v_cvt_pk_bf16_f32 v50, v18, v34
  v_cvt_pk_bf16_f32 v51, v19, v35
  v_cvt_pk_bf16_f32 v52, v20, v36
  v_cvt_pk_bf16_f32 v53, v21, v37
  v_cvt_pk_bf16_f32 v54, v22, v38
  v_cvt_pk_bf16_f32 v55, v23, v39
  v_cvt_pk_bf16_f32 v56, v24, v40
  v_cvt_pk_bf16_f32 v57, v25, v41
  v_cvt_pk_bf16_f32 v58, v26, v42
  v_cvt_pk_bf16_f32 v59, v27, v43
  v_cvt_pk_bf16_f32 v60, v28, v44
  v_cvt_pk_bf16_f32 v61, v29, v45
  v_cvt_pk_bf16_f32 v62, v30, v46
  v_cvt_pk_bf16_f32 v63, v31, v47
  v_cvt_pk_bf16_f32 v64, -v32, v16
  v_cvt_pk_bf16_f32 v65, -v33, v17
  v_cvt_pk_bf16_f32 v66, -v34, v18
  v_cvt_pk_bf16_f32 v67, -v35, v19
  v_cvt_pk_bf16_f32 v68, -v36, v20
  v_cvt_pk_bf16_f32 v69, -v37, v21
  v_cvt_pk_bf16_f32 v70, -v38, v22
  v_cvt_pk_bf16_f32 v71, -v39, v23
  v_cvt_pk_bf16_f32 v72, -v40, v24
  v_cvt_pk_bf16_f32 v73, -v41, v25
  v_cvt_pk_bf16_f32 v74, -v42, v26
  v_cvt_pk_bf16_f32 v75, -v43, v27
  v_cvt_pk_bf16_f32 v76, -v44, v28
  v_cvt_pk_bf16_f32 v77, -v45, v29
  v_cvt_pk_bf16_f32 v78, -v46, v30
  v_cvt_pk_bf16_f32 v79, -v47, v31
  s_lshr_b32 s28, s61, 1
  s_lshr_b32 s27, s28, 7
  s_lshl_b32 s27, s27, 5
  s_and_b32 s26, s28, 31
  s_add_u32 s27, s27, s26
  s_lshr_b32 s26, s28, 5
  s_and_b32 s26, s26, 3
  v_bfe_u32 v4, v1, 2, 2
  v_xor_b32 v4, s26, v4
  v_lshlrev_b32 v4, 4, v4
  v_mul_u32_u24 v11, 128, v1
  v_add_u32 v10, v4, v11
  v_mul_u32_u24 v11, 128, v1
  s_mov_b32 s30, s27
  s_lshr_b32 s27, s30, 6
  s_lshl_b32 s27, s27, 5
  s_and_b32 s31, s30, 31
  s_add_u32 s27, s27, s31
  s_mul_i32 s27, s27, 32768
  s_bfe_u32 s31, s30, 0x10005
  s_lshl_b32 s31, s31, 6
  s_add_u32 s27, s27, s31
  s_waitcnt vmcnt(0)
  s_mov_b32 s45, 0
  s_mov_b32 s46, 8192
  s_mov_b32 s47, 16384
  s_mov_b32 s48, 24576
S_POLL:
  buffer_load_dword v4, v11, s[32:35], 0 offen sc0 sc1
  buffer_load_dword v5, v11, s[32:35], s46 offen sc0 sc1
  buffer_load_dword v6, v11, s[32:35], s47 offen sc0 sc1
  buffer_load_dword v7, v11, s[32:35], s48 offen sc0 sc1
  s_waitcnt vmcnt(0)
  v_and_b32 v4, v4, v5
  v_and_b32 v6, v6, v7
  v_and_b32 v4, v4, v6
  v_cmp_ne_u32 vcc, 1, v4
  s_nop 4
  s_cmp_eq_u64 vcc, 0
  s_cbranch_scc1 S_POLL_OK
  s_add_u32 s45, s45, 1
  s_cmp_lt_u32 s45, 20000
  s_cbranch_scc1 S_POLL
S_POLL_OK:
  s_barrier
  buffer_load_dwordx4 v[144:147], v10, s[16:19], s27 offen sc1
  s_add_u32 s27, s27, 8192
  buffer_load_dwordx4 v[148:151], v10, s[16:19], s27 offen sc1
  s_add_u32 s27, s27, 8192
  buffer_load_dwordx4 v[152:155], v10, s[16:19], s27 offen sc1
  s_add_u32 s27, s27, 8192
  buffer_load_dwordx4 v[156:159], v10, s[16:19], s27 offen sc1
  s_waitcnt vmcnt(3)
  v_mfma_f32_32x32x16_bf16 v[16:31], v[144:147], v[48:51], 0
  v_mfma_f32_32x32x16_bf16 v[32:47], v[144:147], v[64:67], 0
  s_waitcnt vmcnt(2)
  v_mfma_f32_32x32x16_bf16 v[16:31], v[148:151], v[52:55], v[16:31]
  v_mfma_f32_32x32x16_bf16 v[32:47], v[148:151], v[68:71], v[32:47]
  s_waitcnt vmcnt(1)
  v_mfma_f32_32x32x16_bf16 v[16:31], v[152:155], v[56:59], v[16:31]
  v_mfma_f32_32x32x16_bf16 v[32:47], v[152:155], v[72:75], v[32:47]
  s_waitcnt vmcnt(0)
  v_mfma_f32_32x32x16_bf16 v[16:31], v[156:159], v[60:63], v[16:31]
  v_mfma_f32_32x32x16_bf16 v[32:47], v[156:159], v[76:79], v[32:47]
  s_nop 10
  v_pk_mul_f32 v[4:5], v[16:17], v[80:81]
  v_pk_fma_f32 v[4:5], v[32:33], v[96:97], v[4:5]
  v_pk_mul_f32 v[32:33], v[32:33], v[80:81]
  v_pk_fma_f32 v[32:33], v[16:17], v[96:97], v[32:33] neg_lo:[1,0,0] neg_hi:[1,0,0]
  v_cvt_pk_bf16_f32 v144, v4, v32
  v_cvt_pk_bf16_f32 v145, v5, v33
  v_pk_mul_f32 v[6:7], v[18:19], v[82:83]
  v_pk_fma_f32 v[6:7], v[34:35], v[98:99], v[6:7]
  v_pk_mul_f32 v[34:35], v[34:35], v[82:83]
  v_pk_fma_f32 v[34:35], v[18:19], v[98:99], v[34:35] neg_lo:[1,0,0] neg_hi:[1,0,0]
  v_cvt_pk_bf16_f32 v146, v6, v34
  v_cvt_pk_bf16_f32 v147, v7, v35
  v_pk_mul_f32 v[14:15], v[20:21], v[84:85]
  v_pk_fma_f32 v[14:15], v[36:37], v[100:101], v[14:15]
  v_pk_mul_f32 v[36:37], v[36:37], v[84:85]
  v_pk_fma_f32 v[36:37], v[20:21], v[100:101], v[36:37] neg_lo:[1,0,0] neg_hi:[1,0,0]
  v_cvt_pk_bf16_f32 v148, v14, v36
  v_cvt_pk_bf16_f32 v149, v15, v37
  v_pk_mul_f32 v[4:5], v[22:23], v[86:87]
  v_pk_fma_f32 v[4:5], v[38:39], v[102:103], v[4:5]
  v_pk_mul_f32 v[38:39], v[38:39], v[86:87]
  v_pk_fma_f32 v[38:39], v[22:23], v[102:103], v[38:39] neg_lo:[1,0,0] neg_hi:[1,0,0]
  v_cvt_pk_bf16_f32 v150, v4, v38
  v_cvt_pk_bf16_f32 v151, v5, v39
  v_pk_mul_f32 v[6:7], v[24:25], v[88:89]
  v_pk_fma_f32 v[6:7], v[40:41], v[104:105], v[6:7]
  v_pk_mul_f32 v[40:41], v[40:41], v[88:89]
  v_pk_fma_f32 v[40:41], v[24:25], v[104:105], v[40:41] neg_lo:[1,0,0] neg_hi:[1,0,0]
  v_cvt_pk_bf16_f32 v152, v6, v40
  v_cvt_pk_bf16_f32 v153, v7, v41
  v_pk_mul_f32 v[14:15], v[26:27], v[90:91]
  v_pk_fma_f32 v[14:15], v[42:43], v[106:107], v[14:15]
  v_pk_mul_f32 v[42:43], v[42:43], v[90:91]
  v_pk_fma_f32 v[42:43], v[26:27], v[106:107], v[42:43] neg_lo:[1,0,0] neg_hi:[1,0,0]
  v_cvt_pk_bf16_f32 v154, v14, v42
  v_cvt_pk_bf16_f32 v155, v15, v43
  v_pk_mul_f32 v[4:5], v[28:29], v[92:93]
  v_pk_fma_f32 v[4:5], v[44:45], v[108:109], v[4:5]
  v_pk_mul_f32 v[44:45], v[44:45], v[92:93]
  v_pk_fma_f32 v[44:45], v[28:29], v[108:109], v[44:45] neg_lo:[1,0,0] neg_hi:[1,0,0]
  v_cvt_pk_bf16_f32 v156, v4, v44
  v_cvt_pk_bf16_f32 v157, v5, v45
  v_pk_mul_f32 v[6:7], v[30:31], v[94:95]
  v_pk_fma_f32 v[6:7], v[46:47], v[110:111], v[6:7]
  v_pk_mul_f32 v[46:47], v[46:47], v[94:95]
  v_pk_fma_f32 v[46:47], v[30:31], v[110:111], v[46:47] neg_lo:[1,0,0] neg_hi:[1,0,0]
  v_cvt_pk_bf16_f32 v158, v6, v46
  v_cvt_pk_bf16_f32 v159, v7, v47
  v_mfma_f32_32x32x16_bf16 v[16:31], v[144:147], v[48:51], 0
  v_mfma_f32_32x32x16_bf16 v[32:47], v[144:147], v[64:67], 0
  v_mfma_f32_32x32x16_bf16 v[16:31], v[148:151], v[52:55], v[16:31]
  v_mfma_f32_32x32x16_bf16 v[32:47], v[148:151], v[68:71], v[32:47]
  v_mfma_f32_32x32x16_bf16 v[16:31], v[152:155], v[56:59], v[16:31]
  v_mfma_f32_32x32x16_bf16 v[32:47], v[152:155], v[72:75], v[32:47]
  v_mfma_f32_32x32x16_bf16 v[16:31], v[156:159], v[60:63], v[16:31]
  v_mfma_f32_32x32x16_bf16 v[32:47], v[156:159], v[76:79], v[32:47]
  v_and_b32 v4, 31, v1
  v_lshlrev_b32 v4, 7, v4
  v_lshrrev_b32 v5, 5, v1
  v_lshlrev_b32 v5, 4, v5
  v_add_u32 v4, v4, v5
  s_nop 11
  s_bitcmp1_b32 s61, 0
  s_cbranch_scc1 S_ODD
  ds_write_b128 v4, v[16:19] offset:1024
  ds_write_b128 v4, v[20:23] offset:1056
  ds_write_b128 v4, v[24:27] offset:1088
  ds_write_b128 v4, v[28:31] offset:1120
  s_branch S_Y
S_ODD:
  v_sub_f32 v32, 0, v32
  v_sub_f32 v33, 0, v33
  v_sub_f32 v34, 0, v34
  v_sub_f32 v35, 0, v35
  v_sub_f32 v36, 0, v36
  v_sub_f32 v37, 0, v37
  v_sub_f32 v38, 0, v38
  v_sub_f32 v39, 0, v39
  v_sub_f32 v40, 0, v40
  v_sub_f32 v41, 0, v41
  v_sub_f32 v42, 0, v42
  v_sub_f32 v43, 0, v43
  v_sub_f32 v44, 0, v44
  v_sub_f32 v45, 0, v45
  v_sub_f32 v46, 0, v46
  v_sub_f32 v47, 0, v47
  ds_write_b128 v4, v[32:35] offset:1024
  ds_write_b128 v4, v[36:39] offset:1056
  ds_write_b128 v4, v[40:43] offset:1088
  ds_write_b128 v4, v[44:47] offset:1120
  s_branch S_Y
S_WAIT:
  s_barrier
S_Y:
  v_lshrrev_b32 v4, 3, v0
  v_lshlrev_b32 v4, 12, v4
  v_and_b32 v5, 7, v0
  v_lshlrev_b32 v5, 4, v5
  v_add_u32 v4, v4, v5
  s_lshl_b32 s50, s68, 7
  s_add_u32 s51, s50, 131072
  s_add_u32 s52, s50, 262144
  s_add_u32 s53, s50, 393216
  s_add_u32 s54, s50, 524288
  s_add_u32 s55, s50, 655360
  s_add_u32 s56, s50, 786432
  s_mov_b32 s49, 0
S_YPOLL:
  buffer_load_dwordx4 v[168:171], v4, s[12:15], s50 offen sc0 sc1
  buffer_load_dwordx4 v[172:175], v4, s[12:15], s51 offen sc0 sc1
  buffer_load_dwordx4 v[176:179], v4, s[12:15], s52 offen sc0 sc1
  buffer_load_dwordx4 v[180:183], v4, s[12:15], s53 offen sc0 sc1
  buffer_load_dwordx4 v[184:187], v4, s[12:15], s54 offen sc0 sc1
  buffer_load_dwordx4 v[188:191], v4, s[12:15], s55 offen sc0 sc1
  buffer_load_dwordx4 v[192:195], v4, s[12:15], s56 offen sc0 sc1
  s_waitcnt vmcnt(0)
  v_max3_u32 v5, v168, v169, v170
  v_max3_u32 v5, v5, v171, v172
  v_max3_u32 v5, v5, v173, v174
  v_max3_u32 v5, v5, v175, v176
  v_max3_u32 v5, v5, v177, v178
  v_max3_u32 v5, v5, v179, v180
  v_max3_u32 v5, v5, v181, v182
  v_max3_u32 v5, v5, v183, v184
  v_max3_u32 v5, v5, v185, v186
  v_max3_u32 v5, v5, v187, v188
  v_max3_u32 v5, v5, v189, v190
  v_max3_u32 v5, v5, v191, v192
  v_max3_u32 v5, v5, v193, v194
  v_max_u32 v5, v5, v195
  v_cmp_eq_u32 vcc, -1, v5
  s_nop 4
  s_cmp_eq_u64 vcc, 0
  s_cbranch_scc1 S_YOK
  s_add_u32 s49, s49, 1
  s_cmp_lt_u32 s49, 20000
  s_cbranch_scc1 S_YPOLL
S_YOK:
  v_add_f32 v168, v168, v172
  v_add_f32 v176, v176, v180
  v_add_f32 v184, v184, v188
  v_add_f32 v169, v169, v173
  v_add_f32 v177, v177, v181
  v_add_f32 v185, v185, v189
  v_add_f32 v170, v170, v174
  v_add_f32 v178, v178, v182
  v_add_f32 v186, v186, v190
  v_add_f32 v171, v171, v175
  v_add_f32 v179, v179, v183
  v_add_f32 v187, v187, v191
  v_add_f32 v168, v168, v176
  v_add_f32 v184, v184, v192
  v_add_f32 v169, v169, v177
  v_add_f32 v185, v185, v193
  v_add_f32 v170, v170, v178
  v_add_f32 v186, v186, v194
  v_add_f32 v171, v171, v179
  v_add_f32 v187, v187, v195
  v_add_f32 v168, v168, v184
  v_add_f32 v169, v169, v185
  v_add_f32 v170, v170, v186
  v_add_f32_e64 v171, v171, v187
  v_add_f32_dpp v168, v168, v168 row_ror:8 row_mask:0xf bank_mask:0xf
  v_add_f32_dpp v169, v169, v169 row_ror:8 row_mask:0xf bank_mask:0xf
  v_add_f32_dpp v170, v170, v170 row_ror:8 row_mask:0xf bank_mask:0xf
  v_add_f32_dpp v171, v171, v171 row_ror:8 row_mask:0xf bank_mask:0xf
  v_mov_b32 v172, v168
  v_mov_b32 v173, v169
  v_mov_b32 v174, v170
  v_mov_b32 v175, v171
  v_permlane16_swap_b32 v172, v168
  v_permlane16_swap_b32 v173, v169
  v_permlane16_swap_b32 v174, v170
  v_permlane16_swap_b32 v175, v171
  v_add_f32 v168, v168, v172
  v_add_f32 v169, v169, v173
  v_add_f32 v170, v170, v174
  v_add_f32 v171, v171, v175
  v_mov_b32 v172, v168
  v_mov_b32 v173, v169
  v_mov_b32 v174, v170
  v_mov_b32 v175, v171
  v_permlane32_swap_b32 v172, v168
  v_permlane32_swap_b32 v173, v169
  v_permlane32_swap_b32 v174, v170
  v_permlane32_swap_b32 v175, v171
  v_add_f32 v168, v168, v172
  v_add_f32 v169, v169, v173
  v_add_f32 v170, v170, v174
  v_add_f32 v171, v171, v175
  v_lshlrev_b32 v4, 4, v1
  s_lshl_b32 s29, s3, 7
  v_add_u32 v4, s29, v4
  s_mov_b64 exec, 0xff
  ds_write_b128 v4, v[168:171] offset:64
  s_mov_b64 exec, -1
  s_waitcnt lgkmcnt(0)
  s_barrier
  s_cmp_eq_u32 s3, 0
  s_cbranch_scc1 S_FIN
  s_endpgm
S_FIN:
  v_and_b32 v6, 31, v1
  v_lshlrev_b32 v5, 2, v6
  ds_read_b32 v8, v5 offset:64
  ds_read_b32 v9, v5 offset:192
  ds_read_b32 v10, v5 offset:320
  ds_read_b32 v11, v5 offset:448
  s_lshl_b32 s29, s68, 7
  v_add_u32 v4, s29, v5
  ds_read_b32 v12, v4 offset:1024
  s_waitcnt lgkmcnt(3)
  v_add_f32 v8, v8, v9
  s_waitcnt lgkmcnt(1)
  v_add_f32 v10, v10, v11
  v_add_f32 v8, v8, v10
  v_cvt_pk_bf16_f32 v8, v8, v8
  v_lshlrev_b32 v8, 16, v8
  v_mul_f32 v8, v164, v8
  v_cvt_pk_bf16_f32 v8, v8, v8
  v_lshlrev_b32 v8, 16, v8
  v_lshlrev_b32 v160, 16, v160
  v_fma_f32 v13, v160, v162, v163
  v_cvt_pk_bf16_f32 v13, v13, v13
  v_lshlrev_b32 v13, 16, v13
  v_add_f32 v13, v13, v8
  v_cvt_pk_bf16_f32 v13, v13, v13
  v_lshlrev_b32 v13, 16, v13
  v_mul_f32 v14, 0xbfb8aa3b, v13
  v_exp_f32 v14, v14
  s_nop 0
  v_add_f32 v14, 1.0, v14
  v_rcp_f32 v14, v14
  s_nop 0
  v_mul_f32 v13, v13, v14
  v_cvt_pk_bf16_f32 v13, v13, v13
  v_lshlrev_b32 v13, 16, v13
  s_waitcnt lgkmcnt(0)
  v_mul_f32 v12, 0x35000000, v12
  v_cvt_pk_bf16_f32 v12, v12, v12
  v_lshlrev_b32 v12, 16, v12
  v_mul_f32 v12, v12, v13
  v_cvt_pk_bf16_f32 v12, v12, v12
  v_lshlrev_b32 v12, 16, v12
  v_add_f32 v12, v12, v160
  v_cvt_pk_bf16_f32 v12, v12, v12
  v_lshlrev_b32 v7, 1, v6
  s_mov_b32 s50, -1
  s_mov_b32 s51, 0
  s_mov_b64 exec, s[50:51]
  buffer_store_short v12, v7, s[36:39], s24 offen sc0 sc1
  s_endpgm
CODE_END:
.section .rodata,"a"
.p2align 6
.amdhsa_kernel fft_k1_kernel
  .amdhsa_next_free_vgpr 240
  .amdhsa_next_free_sgpr 80
  .amdhsa_accum_offset 240
  .amdhsa_group_segment_fixed_size 0
  .amdhsa_kernarg_size 88
  .amdhsa_user_sgpr_count 2
  .amdhsa_user_sgpr_kernarg_segment_ptr 1
  .amdhsa_system_sgpr_workgroup_id_x 1
  .amdhsa_float_denorm_mode_32 3
.end_amdhsa_kernel
.p2align 6
.amdhsa_kernel fft_k23_kernel
  .amdhsa_next_free_vgpr 256
  .amdhsa_next_free_sgpr 80
  .amdhsa_accum_offset 256
  .amdhsa_group_segment_fixed_size 0
  .amdhsa_kernarg_size 88
  .amdhsa_user_sgpr_count 2
  .amdhsa_user_sgpr_kernarg_segment_ptr 1
  .amdhsa_system_sgpr_workgroup_id_x 1
  .amdhsa_float_denorm_mode_32 3
.end_amdhsa_kernel
```
